```python
import torch

def _softmax(x, axis=-1):
    return torch.softmax(x, dim=axis)

def _gelu(x):
    return torch.nn.functional.gelu(x, approximate='tanh')

def _silu(x):
    return torch.nn.functional.silu(x)

def _sigmoid(x):
    return torch.sigmoid(x)

def _layernorm(x, axis=-1, eps=1e-05):
    m = x.mean(dim=axis, keepdim=True)
    v = x.var(dim=axis, keepdim=True, unbiased=False)
    return (x - m) / torch.sqrt(v + eps)

def _scatter_add(tgt, idx, src, axis=0):
    return tgt.clone().index_add_(axis, idx, src)

def _segment_sum(src, seg, n):
    out = torch.zeros((n,) + src.shape[1:], dtype=src.dtype)
    return out.index_add_(0, seg, src)

def _pad(x, pw):
    flat = tuple((v for pair in reversed(pw) for v in pair))
    return torch.nn.functional.pad(x, flat)
kernel_name = 'adaLN_cond__sliding_block_cached__glu_gated_bilinear__decode'

def setup_inputs():

    _w = lambda a: (lambda t: t.to(torch.bfloat16) if t.is_floating_point() else t)(torch.as_tensor(a))

    def _A_setup():
        B, Sq, D = (2, 1, 512)
        Hq, Hkv, Sk, Dh = (32, 8, 32768, 128)
        assert Hq % Hkv == 0, (Hq, Hkv)
        return {'x': _w((lambda *s: torch.randn(*s, dtype=torch.bfloat16) * 0.05)(B, Sq, D)), 'k_cache': _w((lambda *s: torch.randn(*s, dtype=torch.bfloat16) * 3.2)(B, Hkv, Sk, Dh)), 'v_cache': _w((lambda *s: torch.randn(*s, dtype=torch.bfloat16) * 3.2)(B, Hkv, Sk, Dh)), 'wq': _w((lambda *s: torch.randn(*s, dtype=torch.bfloat16) * 3.2)(D, Hq * Dh) * D ** (-0.5)), 'wo': _w((lambda *s: torch.randn(*s, dtype=torch.bfloat16) * 3.2)(Hq * Dh, D) * (Hq * Dh) ** (-0.5))}
    _A_in = _A_setup()

    def _B_setup():
        B, S, D, F = (2, 1, 512, 1792)
        return {'x': _w((lambda *s: torch.randn(*s, dtype=torch.bfloat16) * 0.05)(B, S, D)), 'w_gate': _w((lambda *s: torch.randn(*s, dtype=torch.bfloat16) * 3.2)(D, F) * D ** (-0.5)), 'w_up': _w((lambda *s: torch.randn(*s, dtype=torch.bfloat16) * 3.2)(D, F) * D ** (-0.5)), 'w_down': _w((lambda *s: torch.randn(*s, dtype=torch.bfloat16) * 3.2)(F, D) * F ** (-0.5))}
    _B_in = _B_setup()
    return {'A_x': _A_in['x'], 'A_k_cache': _A_in['k_cache'], 'A_v_cache': _A_in['v_cache'], 'A_wq': _A_in['wq'], 'A_wo': _A_in['wo'], 'B_x': _B_in['x'], 'B_w_gate': _B_in['w_gate'], 'B_w_up': _B_in['w_up'], 'B_w_down': _B_in['w_down'], 'c': _w((lambda *s: torch.randn(*s, dtype=torch.bfloat16) * 0.2)(2, 512) * 8.0), 'w_mod': _w((lambda *s: torch.randn(*s, dtype=torch.bfloat16) * 0.2)(512, 6 * 512) * 512 ** (-0.5) * 8.0)}

def reference(A_x, A_k_cache, A_v_cache, A_wq, A_wo, B_x, B_w_gate, B_w_up, B_w_down, c, w_mod):

    def _A_ref(x, k_cache, v_cache, wq, wo):
        B, Sq, D = x.shape
        Hq, Dh = (32, 128)
        Hkv, Sk = (k_cache.shape[1], k_cache.shape[2])
        W = min(4096, max(256, Sk // 4))
        rep = Hq // Hkv
        q = (lambda x, *d: x.permute(*d))((x @ wq).reshape(B, Sq, Hq, Dh), 0, 2, 1, 3)
        k = (lambda x, n, axis: torch.repeat_interleave(x, n, dim=axis))(k_cache[:, :, Sk - W:, :], rep, axis=1)
        v = (lambda x, n, axis: torch.repeat_interleave(x, n, dim=axis))(v_cache[:, :, Sk - W:, :], rep, axis=1)
        scores = torch.einsum('bhqd,bhkd->bhqk', q, k) * Dh ** (-0.5)
        p = _softmax(scores, axis=-1)
        o = torch.einsum('bhqk,bhkd->bhqd', p, v)
        return (lambda x, *d: x.permute(*d))(o, 0, 2, 1, 3).reshape(B, Sq, Hq * Dh) @ wo

    def _B_ref(x, w_gate, w_up, w_down):
        g = torch.einsum('bsd,df->bsf', x, w_gate)
        u = torch.einsum('bsd,df->bsf', x, w_up)
        h = g * u
        return torch.einsum('bsf,fd->bsd', h, w_down)
    x = A_x
    mod = (_silu(c) @ w_mod).reshape(c.shape[0], 6, 1, -1)
    sa, ca, ga, sb, cb, gb = (mod[:, 0].clone(), mod[:, 1].clone(), mod[:, 2].clone(), mod[:, 3].clone(), mod[:, 4].clone(), mod[:, 5].clone())
    h = _layernorm(x, axis=-1) * (1 + ca) + sa
    x = x + ga * _A_ref(h, A_k_cache, A_v_cache, A_wq, A_wo)
    h = _layernorm(x, axis=-1) * (1 + cb) + sb
    x = x + gb * _B_ref(h, B_w_gate, B_w_up, B_w_down)
    return x
```

```asm
; @launch grid=(256,1,1) block=(576,1,1) lds=159744
.amdgcn_target "amdgcn-amd-amdhsa--gfx950"
.text
.globl adaLN_cond__sliding_block_cached__glu_gated_bilinear__decode_kernel
.p2align 8
.type adaLN_cond__sliding_block_cached__glu_gated_bilinear__decode_kernel,@function
adaLN_cond__sliding_block_cached__glu_gated_bilinear__decode_kernel:
    s_cmp_ge_u32 s2, 256
    s_cbranch_scc1 L_end
    s_load_dwordx16 s[16:31], s[0:1], 0
    s_load_dwordx8 s[32:39], s[0:1], 64
    s_load_dwordx4 s[40:43], s[0:1], 96
    v_lshrrev_b32 v1, 6, v0
    v_and_b32 v0, 63, v0
    v_readfirstlane_b32 s3, v1
    s_and_b32 s4, s2, 7
    s_lshr_b32 s5, s2, 3
    s_cmp_lt_u32 s5, 8
    s_cselect_b32 s6, 1, 0
    s_cselect_b32 s90, 0, 8
    s_sub_u32 s7, s5, s90
    s_cmp_lt_u32 s5, 8
    s_cselect_b32 s91, 4, 12
    s_cselect_b32 s94, 0, 4
    s_cmp_ge_u32 s7, s91
    s_cselect_b32 s86, 1, 0
    s_mul_i32 s90, s86, s91
    s_sub_u32 s87, s7, s90
    s_add_u32 s87, s87, s94
    s_lshr_b32 s8, s5, 3
    s_and_b32 s9, s5, 7
    s_mov_b32 s11, 4194304
    s_mov_b32 s88, 2
    s_cmp_lg_u32 s3, 8
    s_cbranch_scc1 L_worker
    v_lshrrev_b32 v3, 3, v0
    v_bfe_u32 v4, v0, 4, 1
    v_lshlrev_b32 v4, 1, v4
    v_and_b32 v5, 7, v0
    v_xor_b32 v4, v4, v5
    v_lshlrev_b32 v4, 4, v4
    v_mul_u32_u24 v6, 6144, v3
    v_add_u32 v20, v6, v4
    v_xor_b32 v21, 64, v20
    s_and_b32 s90, s7, 3
    s_mul_i32 s96, s90, 786432
    s_lshr_b32 s90, s7, 2
    s_lshl_b32 s94, s4, 2
    s_add_u32 s94, s94, 16
    s_lshl_b32 s91, s4, 1
    s_sub_u32 s91, s91, 4
    s_cmp_ge_u32 s7, 16
    s_cselect_b32 s94, s91, s94
    s_add_u32 s90, s90, s94
    s_lshl_b32 s90, s90, 7
    s_add_u32 s96, s96, s90
    s_mov_b32 m0, 143360
    s_waitcnt lgkmcnt(0)
    s_mov_b32 s44, s36
    s_and_b32 s45, s37, 0xffff
    s_mov_b32 s46, 3145728
    s_mov_b32 s47, 0x20000
    s_cmp_lt_u32 s5, 24
    s_cbranch_scc1 L_ld_nourg
    buffer_load_dwordx4 v20, s[44:47], s96 offen nt lds
    s_add_u32 s96, s96, 49152
    s_add_u32 m0, m0, 0x400
    s_nop 0
    buffer_load_dwordx4 v21, s[44:47], s96 offen nt lds
    s_add_u32 s96, s96, 49152
    s_add_u32 m0, m0, 0x400
    s_nop 0
    buffer_load_dwordx4 v20, s[44:47], s96 offen nt lds
    s_add_u32 s96, s96, 49152
    s_add_u32 m0, m0, 0x400
    s_nop 0
    buffer_load_dwordx4 v21, s[44:47], s96 offen nt lds
    s_add_u32 s96, s96, 49152
    s_add_u32 m0, m0, 0x400
    s_nop 0
    buffer_load_dwordx4 v20, s[44:47], s96 offen nt lds
    s_add_u32 s96, s96, 49152
    s_add_u32 m0, m0, 0x400
    s_nop 0
    buffer_load_dwordx4 v21, s[44:47], s96 offen nt lds
    s_add_u32 s96, s96, 49152
    s_add_u32 m0, m0, 0x400
    s_nop 0
    buffer_load_dwordx4 v20, s[44:47], s96 offen nt lds
    s_add_u32 s96, s96, 49152
    s_add_u32 m0, m0, 0x400
    s_nop 0
    buffer_load_dwordx4 v21, s[44:47], s96 offen nt lds
    s_add_u32 s96, s96, 49152
    s_add_u32 m0, m0, 0x400
    s_nop 0
    buffer_load_dwordx4 v20, s[44:47], s96 offen nt lds
    s_add_u32 s96, s96, 49152
    s_add_u32 m0, m0, 0x400
    s_nop 0
    buffer_load_dwordx4 v21, s[44:47], s96 offen nt lds
    s_add_u32 s96, s96, 49152
    s_add_u32 m0, m0, 0x400
    s_nop 0
    buffer_load_dwordx4 v20, s[44:47], s96 offen nt lds
    s_add_u32 s96, s96, 49152
    s_add_u32 m0, m0, 0x400
    s_nop 0
    buffer_load_dwordx4 v21, s[44:47], s96 offen nt lds
    s_add_u32 s96, s96, 49152
    s_add_u32 m0, m0, 0x400
    s_nop 0
    buffer_load_dwordx4 v20, s[44:47], s96 offen nt lds
    s_add_u32 s96, s96, 49152
    s_add_u32 m0, m0, 0x400
    s_nop 0
    buffer_load_dwordx4 v21, s[44:47], s96 offen nt lds
    s_add_u32 s96, s96, 49152
    s_add_u32 m0, m0, 0x400
    s_nop 0
    buffer_load_dwordx4 v20, s[44:47], s96 offen nt lds
    s_add_u32 s96, s96, 49152
    s_add_u32 m0, m0, 0x400
    s_nop 0
    buffer_load_dwordx4 v21, s[44:47], s96 offen nt lds
L_ld_nourg:
    s_barrier
    s_mov_b32 s12, s42
    s_and_b32 s13, s43, 0xffff
    s_mov_b32 s14, 3145728
    s_mov_b32 s15, 0x20000
    s_mov_b32 s52, s18
    s_and_b32 s53, s19, 0xffff
    s_mov_b32 s54, 134217728
    s_mov_b32 s55, 0x20000
    s_mov_b32 s56, s20
    s_and_b32 s57, s21, 0xffff
    s_mov_b32 s58, 134217728
    s_mov_b32 s59, 0x20000
    s_mov_b32 s60, s24
    s_and_b32 s61, s25, 0xffff
    s_mov_b32 s62, 4194304
    s_mov_b32 s63, 0x20000
    v_mov_b32 v10, 0
    v_lshrrev_b32 v3, 4, v0
    v_and_b32 v4, 15, v0
    v_xor_b32 v5, v4, v3
    v_lshlrev_b32 v5, 4, v5
    v_lshl_add_u32 v26, v3, 8, v5
    v_xor_b32 v27, 64, v26
    v_xor_b32 v28, 0x80, v26
    v_xor_b32 v29, 0xc0, v26
    v_lshlrev_b32 v5, 1, v3
    v_xor_b32 v5, v4, v5
    v_lshlrev_b32 v5, 4, v5
    v_lshl_add_u32 v30, v3, 8, v5
    v_xor_b32 v31, 0x80, v30
    s_mul_i32 s91, s6, -32768
    s_add_u32 s91, s91, 73728
    s_mul_i32 s90, s87, s91
    s_mul_i32 s91, s6, 131072
    s_add_u32 s90, s90, s91
    s_lshl_b32 s98, s86, 26
    s_lshl_b32 s94, s4, 23
    s_add_u32 s98, s98, s94
    s_mov_b32 s94, s90
    s_add_u32 s98, s98, s94
    s_add_u32 s98, s98, 7208960
    v_lshrrev_b32 v3, 3, v0
    v_bfe_u32 v4, v0, 4, 1
    v_lshlrev_b32 v4, 1, v4
    v_and_b32 v5, 7, v0
    v_xor_b32 v4, v4, v5
    v_lshlrev_b32 v4, 4, v4
    v_lshlrev_b32 v6, 10, v3
    v_add_u32 v24, v6, v4
    v_xor_b32 v25, 64, v24
    s_cmp_eq_u32 s6, 0
    s_cbranch_scc1 L_ld_A
Lsp_1:
    ds_read_b32 v12, v10 offset:68
    s_waitcnt lgkmcnt(0)
    v_readfirstlane_b32 s91, v12
    s_nop 0
    s_cmp_ge_i32 s91, 4
    s_cbranch_scc1 Lspe_2
    s_sub_u32 s11, s11, 1
    s_cbranch_scc1 L_abort
    s_branch Lsp_1
Lspe_2:
    s_mov_b32 s95, -12
    s_mov_b32 s96, s98
    s_mov_b32 m0, 12288
    s_mov_b32 s97, 10
L_ld_kB:
    buffer_load_dwordx4 v26, s[52:55], s96 offen offset:0 nt lds
    buffer_load_dwordx4 v27, s[52:55], s96 offen offset:1024 nt lds
    buffer_load_dwordx4 v28, s[52:55], s96 offen offset:2048 nt lds
    buffer_load_dwordx4 v29, s[52:55], s96 offen offset:3072 nt lds
    s_add_u32 s96, s96, 0x1000
    s_add_u32 m0, m0, 0x1000
    s_add_u32 s95, s95, 4
    v_mov_b32 v11, s95
    s_waitcnt vmcnt(12)
    ds_write_b32 v10, v11 offset:0
    s_sub_u32 s97, s97, 1
    s_cmp_lg_u32 s97, 0
    s_cbranch_scc1 L_ld_kB
    s_waitcnt vmcnt(0)
    v_mov_b32 v11, 40
    ds_write_b32 v10, v11 offset:0
Lsp_3:
    ds_read_b32 v12, v10 offset:64
    s_waitcnt lgkmcnt(0)
    v_readfirstlane_b32 s91, v12
    s_nop 0
    s_cmp_ge_i32 s91, 2
    s_cbranch_scc1 Lspe_4
    s_sub_u32 s11, s11, 1
    s_cbranch_scc1 L_abort
    s_branch Lsp_3
Lspe_4:
    s_mov_b32 s95, 12
    s_mov_b32 s96, s98
    s_mov_b32 m0, 86016
    s_mov_b32 s97, 10
L_ld_vB:
    buffer_load_dwordx4 v30, s[56:59], s96 offen offset:0 nt lds
    buffer_load_dwordx4 v30, s[56:59], s96 offen offset:1024 nt lds
    buffer_load_dwordx4 v31, s[56:59], s96 offen offset:2048 nt lds
    buffer_load_dwordx4 v31, s[56:59], s96 offen offset:3072 nt lds
    s_add_u32 s96, s96, 0x1000
    s_add_u32 m0, m0, 0x1000
    s_add_u32 s95, s95, 4
    v_mov_b32 v11, s95
    s_waitcnt vmcnt(28)
    ds_max_i32 v10, v11 offset:0
    s_sub_u32 s97, s97, 1
    s_cmp_lg_u32 s97, 0
    s_cbranch_scc1 L_ld_vB
    s_lshl_b32 s96, s4, 19
    s_lshl_b32 s94, s8, 17
    s_add_u32 s96, s96, s94
    s_lshl_b32 s94, s9, 7
    s_add_u32 s96, s96, s94
    s_mov_b32 m0, 53248
    s_mov_b32 s97, 8
L_ld_woB:
    buffer_load_dwordx4 v24, s[60:63], s96 offen nt lds
    s_add_u32 s96, s96, 8192
    s_add_u32 m0, m0, 0x400
    s_nop 0
    buffer_load_dwordx4 v25, s[60:63], s96 offen nt lds
    s_add_u32 s96, s96, 8192
    s_add_u32 m0, m0, 0x400
    s_sub_u32 s97, s97, 1
    s_cmp_lg_u32 s97, 0
    s_cbranch_scc1 L_ld_woB
    s_mov_b32 s48, s32
    s_and_b32 s49, s33, 0xffff
    s_mov_b32 s50, 1835008
    s_mov_b32 s51, 0x20000
    s_mul_i32 s96, s4, 229376
    s_mul_i32 s94, s8, 57344
    s_add_u32 s96, s96, s94
    s_lshl_b32 s94, s9, 7
    s_add_u32 s96, s96, s94
    s_mov_b32 m0, 151552
    s_mov_b32 s97, 4
L_ld_dnB:
    buffer_load_dwordx4 v24, s[48:51], s96 offen nt lds
    s_add_u32 s96, s96, 8192
    s_add_u32 m0, m0, 0x400
    s_nop 0
    buffer_load_dwordx4 v25, s[48:51], s96 offen nt lds
    s_add_u32 s96, s96, 8192
    s_add_u32 m0, m0, 0x400
    s_sub_u32 s97, s97, 1
    s_cmp_lg_u32 s97, 0
    s_cbranch_scc1 L_ld_dnB
    s_waitcnt vmcnt(48)
    v_mov_b32 v11, 56
    ds_write_b32 v10, v11 offset:0
    s_waitcnt vmcnt(40)
    v_mov_b32 v11, 64
    ds_write_b32 v10, v11 offset:0
    s_waitcnt vmcnt(32)
    v_mov_b32 v11, 72
    ds_write_b32 v10, v11 offset:0
    s_waitcnt vmcnt(24)
    v_mov_b32 v11, 80
    ds_write_b32 v10, v11 offset:0
    s_waitcnt vmcnt(8)
    v_mov_b32 v11, 1
    ds_write_b32 v10, v11 offset:72
    s_waitcnt vmcnt(0)
    v_mov_b32 v11, 1
    ds_write_b32 v10, v11 offset:88
    s_endpgm
L_ld_fin:
    s_waitcnt vmcnt(0)
    v_mov_b32 v11, 1
    ds_write_b32 v10, v11 offset:72
    s_endpgm
L_ld_A:
    s_cmp_ge_u32 s7, 16
    s_cbranch_scc1 L_ld_urg
Lsp_5:
    ds_read_b32 v12, v10 offset:4
    s_waitcnt lgkmcnt(0)
    v_readfirstlane_b32 s91, v12
    s_nop 0
    s_cmp_ge_i32 s91, 2
    s_cbranch_scc1 Lspe_6
    s_sub_u32 s11, s11, 1
    s_cbranch_scc1 L_abort
    s_branch Lsp_5
Lspe_6:
    s_mov_b32 m0, 143360
    s_mov_b32 s97, 8
L_ld_mr:
    buffer_load_dwordx4 v20, s[44:47], s96 offen nt lds
    s_add_u32 s96, s96, 49152
    s_add_u32 m0, m0, 0x400
    s_nop 0
    buffer_load_dwordx4 v21, s[44:47], s96 offen nt lds
    s_add_u32 s96, s96, 49152
    s_add_u32 m0, m0, 0x400
    s_sub_u32 s97, s97, 1
    s_cmp_lg_u32 s97, 0
    s_cbranch_scc1 L_ld_mr
    s_branch L_ld_kgo
L_ld_urg:
    s_waitcnt vmcnt(0)
    v_mov_b32 v11, 1
    ds_write_b32 v10, v11 offset:76
Lsp_7:
    ds_read_b32 v12, v10 offset:56
    s_waitcnt lgkmcnt(0)
    v_readfirstlane_b32 s91, v12
    s_nop 0
    s_cmp_ge_i32 s91, 4
    s_cbranch_scc1 Lspe_8
    s_sub_u32 s11, s11, 1
    s_cbranch_scc1 L_abort
    s_branch Lsp_7
Lspe_8:
L_ld_kgo:
    s_mov_b32 s95, -24
    s_mov_b32 s96, s98
    s_mov_b32 m0, 12288
    s_mov_b32 s97, 6
L_ld_kA0:
    buffer_load_dwordx4 v26, s[52:55], s96 offen offset:0 nt lds
    buffer_load_dwordx4 v27, s[52:55], s96 offen offset:1024 nt lds
    buffer_load_dwordx4 v28, s[52:55], s96 offen offset:2048 nt lds
    buffer_load_dwordx4 v29, s[52:55], s96 offen offset:3072 nt lds
    s_add_u32 s96, s96, 0x1000
    s_add_u32 m0, m0, 0x1000
    s_add_u32 s95, s95, 4
    v_mov_b32 v11, s95
    s_waitcnt vmcnt(24)
    ds_write_b32 v10, v11 offset:0
    s_sub_u32 s97, s97, 1
    s_cmp_lg_u32 s97, 0
    s_cbranch_scc1 L_ld_kA0
    v_mov_b32 v11, 1
    ds_write_b32 v10, v11 offset:76
    s_mov_b32 s97, 12
L_ld_kA:
    buffer_load_dwordx4 v26, s[52:55], s96 offen offset:0 nt lds
    buffer_load_dwordx4 v27, s[52:55], s96 offen offset:1024 nt lds
    buffer_load_dwordx4 v28, s[52:55], s96 offen offset:2048 nt lds
    buffer_load_dwordx4 v29, s[52:55], s96 offen offset:3072 nt lds
    s_add_u32 s96, s96, 0x1000
    s_add_u32 m0, m0, 0x1000
    s_add_u32 s95, s95, 4
    v_mov_b32 v11, s95
    s_waitcnt vmcnt(24)
    ds_write_b32 v10, v11 offset:0
    s_sub_u32 s97, s97, 1
    s_cmp_lg_u32 s97, 0
    s_cbranch_scc1 L_ld_kA
    s_mov_b32 s96, s98
    s_mov_b32 m0, 86016
    s_mov_b32 s97, 14
L_ld_vA:
    buffer_load_dwordx4 v30, s[56:59], s96 offen offset:0 nt lds
    buffer_load_dwordx4 v30, s[56:59], s96 offen offset:1024 nt lds
    buffer_load_dwordx4 v31, s[56:59], s96 offen offset:2048 nt lds
    buffer_load_dwordx4 v31, s[56:59], s96 offen offset:3072 nt lds
    s_add_u32 s96, s96, 0x1000
    s_add_u32 m0, m0, 0x1000
    s_add_u32 s95, s95, 4
    v_mov_b32 v11, s95
    s_waitcnt vmcnt(24)
    ds_write_b32 v10, v11 offset:0
    s_sub_u32 s97, s97, 1
    s_cmp_lg_u32 s97, 0
    s_cbranch_scc1 L_ld_vA
Lsp_9:
    ds_read_b32 v12, v10 offset:16
    s_waitcnt lgkmcnt(0)
    v_readfirstlane_b32 s91, v12
    s_nop 0
    s_cmp_ge_i32 s91, 4
    s_cbranch_scc1 Lspe_10
    s_sub_u32 s11, s11, 1
    s_cbranch_scc1 L_abort
    s_sleep 1
    s_branch Lsp_9
Lspe_10:
    s_mov_b32 s97, 4
L_ld_vA2:
    buffer_load_dwordx4 v30, s[56:59], s96 offen offset:0 nt lds
    buffer_load_dwordx4 v30, s[56:59], s96 offen offset:1024 nt lds
    buffer_load_dwordx4 v31, s[56:59], s96 offen offset:2048 nt lds
    buffer_load_dwordx4 v31, s[56:59], s96 offen offset:3072 nt lds
    s_add_u32 s96, s96, 0x1000
    s_add_u32 m0, m0, 0x1000
    s_add_u32 s95, s95, 4
    v_mov_b32 v11, s95
    s_waitcnt vmcnt(24)
    ds_write_b32 v10, v11 offset:0
    s_sub_u32 s97, s97, 1
    s_cmp_lg_u32 s97, 0
    s_cbranch_scc1 L_ld_vA2
    s_waitcnt vmcnt(16)
    v_mov_b32 v11, 128
    ds_write_b32 v10, v11 offset:0
    s_waitcnt vmcnt(8)
    v_mov_b32 v11, 136
    ds_write_b32 v10, v11 offset:0
    s_waitcnt vmcnt(0)
    v_mov_b32 v11, 144
    ds_write_b32 v10, v11 offset:0
Lsp_11:
    ds_read_b32 v12, v10 offset:20
    s_waitcnt lgkmcnt(0)
    v_readfirstlane_b32 s91, v12
    s_nop 0
    s_cmp_ge_i32 s91, 4
    s_cbranch_scc1 Lspe_12
    s_sub_u32 s11, s11, 1
    s_cbranch_scc1 L_abort
    s_sleep 1
    s_branch Lsp_11
Lspe_12:
    s_lshl_b32 s96, s4, 19
    s_lshl_b32 s94, s8, 17
    s_add_u32 s96, s96, s94
    s_lshl_b32 s94, s9, 7
    s_add_u32 s96, s96, s94
    s_mov_b32 m0, 12288
    s_mov_b32 s97, 8
L_ld_woA:
    buffer_load_dwordx4 v24, s[60:63], s96 offen nt lds
    s_add_u32 s96, s96, 8192
    s_add_u32 m0, m0, 0x400
    s_nop 0
    buffer_load_dwordx4 v25, s[60:63], s96 offen nt lds
    s_add_u32 s96, s96, 8192
    s_add_u32 m0, m0, 0x400
    s_sub_u32 s97, s97, 1
    s_cmp_lg_u32 s97, 0
    s_cbranch_scc1 L_ld_woA
    s_mov_b32 s48, s32
    s_and_b32 s49, s33, 0xffff
    s_mov_b32 s50, 1835008
    s_mov_b32 s51, 0x20000
    s_mul_i32 s96, s4, 229376
    s_mul_i32 s94, s8, 57344
    s_add_u32 s96, s96, s94
    s_lshl_b32 s94, s9, 7
    s_add_u32 s96, s96, s94
    s_mov_b32 m0, 45056
    s_mov_b32 s97, 4
L_ld_dnA:
    buffer_load_dwordx4 v24, s[48:51], s96 offen nt lds
    s_add_u32 s96, s96, 8192
    s_add_u32 m0, m0, 0x400
    s_nop 0
    buffer_load_dwordx4 v25, s[48:51], s96 offen nt lds
    s_add_u32 s96, s96, 8192
    s_add_u32 m0, m0, 0x400
    s_sub_u32 s97, s97, 1
    s_cmp_lg_u32 s97, 0
    s_cbranch_scc1 L_ld_dnA
    s_waitcnt vmcnt(8)
    v_mov_b32 v11, 1
    ds_write_b32 v10, v11 offset:72
    s_waitcnt vmcnt(0)
    v_mov_b32 v11, 1
    ds_write_b32 v10, v11 offset:88
    s_endpgm
L_worker:
    s_cmp_lg_u32 s3, 4
    s_cbranch_scc1 L_wk2
    v_mov_b32 v10, 0
    v_mov_b32 v12, 0
    v_mov_b32 v13, 0
    v_mov_b32 v14, 0
    v_mov_b32 v15, 0
    v_lshlrev_b32 v1, 2, v0
    v_lshlrev_b32 v2, 4, v0
    ds_write_b32 v1, v10
    ds_write_b128 v2, v[12:15] offset:256
L_wk2:
    s_waitcnt lgkmcnt(0)
    s_mov_b32 s12, s42
    s_and_b32 s13, s43, 0xffff
    s_mov_b32 s14, 3145728
    s_mov_b32 s15, 0x20000
    s_mov_b32 s44, s16
    s_and_b32 s45, s17, 0xffff
    s_mov_b32 s46, 2048
    s_mov_b32 s47, 0x20000
    s_mov_b32 s48, s34
    s_and_b32 s49, s35, 0xffff
    s_mov_b32 s50, 2048
    s_mov_b32 s51, 0x20000
    s_sub_u32 s97, s3, 5
    s_and_b32 s97, s97, 1
    s_lshl_b32 s90, s97, 10
    s_and_b32 s94, s7, 3
    s_lshl_b32 s94, s94, 8
    s_add_u32 s94, s94, s90
    v_lshlrev_b32 v1, 4, v0
    v_lshlrev_b32 v2, 2, v0
    s_cmp_lt_u32 s3, 5
    s_cbranch_scc1 L_wk2b
    s_cmp_eq_u32 s3, 7
    s_cbranch_scc1 L_wk2b
    buffer_load_dword v9, v2, s[48:51], s94 offen
    buffer_load_dwordx4 v[4:7], v1, s[44:47], s90 offen
    s_lshr_b32 s94, s7, 1
    s_and_b32 s94, s94, 3
    s_lshl_b32 s94, s94, 8
    s_add_u32 s94, s94, s90
    buffer_load_dword v8, v2, s[44:47], s94 offen
L_wk2b:
    v_mov_b32 v2, 0
    buffer_load_dword v3, v2, s[12:15], 0 offen sc1
    s_cmp_lg_u32 s3, 7
    s_cbranch_scc1 L_wk3
    s_mov_b32 s60, s40
    s_and_b32 s61, s41, 0xffff
    s_mov_b32 s62, 256
    s_mov_b32 s63, 0x20000
    s_getreg_b32 s90, hwreg(HW_REG_XCC_ID)
    s_and_b32 s90, s90, 7
    s_mul_i32 s90, s90, 6
    s_lshl_b64 s[26:27], 1, s90
    s_lshl_b32 s91, s4, 5
    s_add_u32 s91, s91, 8
    v_mov_b32 v18, s91
    v_mov_b32 v16, s26
    v_mov_b32 v17, s27
    s_mov_b64 exec, 1
    buffer_atomic_add_x2 v[16:17], v18, s[60:63], 0 offen sc1
    s_mov_b64 exec, -1
    s_lshl_b32 s90, s86, 26
    s_lshl_b32 s94, s4, 23
    s_add_u32 s90, s90, s94
    s_lshl_b32 s94, s87, 16
    s_add_u32 s90, s90, s94
    s_add_u32 s90, s90, 7340032
    s_load_dword s78, s[18:19], s90
    s_load_dword s79, s[20:21], s90
    s_lshr_b32 s91, s7, 1
    s_and_b32 s91, s91, 3
    s_lshl_b32 s91, s91, 20
    s_load_dword s80, s[22:23], s91
    s_lshl_b32 s91, s4, 19
    s_lshl_b32 s94, s8, 17
    s_add_u32 s91, s91, s94
    s_load_dword s81, s[24:25], s91
    s_mul_i32 s91, s8, 458752
    s_load_dword s82, s[28:29], s91
    s_load_dword s83, s[30:31], s91
    s_mul_i32 s91, s4, 229376
    s_load_dword s84, s[32:33], s91
    s_load_dword s85, s[38:39], 0
L_wk3:
    s_barrier
    s_cmp_ge_u32 s3, 4
    s_cbranch_scc1 L_gwave
L_mwave:
    s_setprio 2
    s_mov_b32 s56, s22
    s_and_b32 s57, s23, 0xffff
    s_mov_b32 s58, 4194304
    s_mov_b32 s59, 0x20000
    v_lshrrev_b32 v1, 4, v0
    v_and_b32 v2, 15, v0
    v_mov_b32 v4, 1
    v_lshlrev_b32 v22, 1, v1
    v_xor_b32 v22, v2, v22
    v_lshlrev_b32 v22, 4, v22
    v_lshl_add_u32 v56, v1, 13, v22
    v_xor_b32 v57, 0x80, v56
    s_lshr_b32 s90, s7, 1
    s_and_b32 s91, s7, 1
    s_lshl_b32 s96, s90, 20
    s_lshl_b32 s94, s4, 10
    s_add_u32 s96, s96, s94
    s_lshl_b32 s94, s91, 9
    s_add_u32 s96, s96, s94
    s_lshl_b32 s94, s3, 18
    s_add_u32 s96, s96, s94
    s_add_u32 s97, s96, 256
    s_cmp_eq_u32 s6, 0
    s_cbranch_scc1 L_m_nowq
    s_lshl_b32 s90, s3, 13
    s_add_u32 m0, s90, 86016
    s_nop 0
    buffer_load_dwordx4 v56, s[56:59], s96 offen nt lds
    s_add_u32 s96, s96, 32768
    s_add_u32 m0, m0, 0x400
    s_nop 0
    buffer_load_dwordx4 v56, s[56:59], s96 offen nt lds
    s_add_u32 s96, s96, 32768
    s_add_u32 m0, m0, 0x400
    s_nop 0
    buffer_load_dwordx4 v57, s[56:59], s96 offen nt lds
    s_add_u32 s96, s96, 32768
    s_add_u32 m0, m0, 0x400
    s_nop 0
    buffer_load_dwordx4 v57, s[56:59], s96 offen nt lds
    s_add_u32 s96, s96, 32768
    s_add_u32 m0, m0, 0x400
    s_nop 0
    buffer_load_dwordx4 v56, s[56:59], s96 offen nt lds
    s_add_u32 s96, s96, 32768
    s_add_u32 m0, m0, 0x400
    s_nop 0
    buffer_load_dwordx4 v56, s[56:59], s96 offen nt lds
    s_add_u32 s96, s96, 32768
    s_add_u32 m0, m0, 0x400
    s_nop 0
    buffer_load_dwordx4 v57, s[56:59], s96 offen nt lds
    s_add_u32 s96, s96, 32768
    s_add_u32 m0, m0, 0x400
    s_nop 0
    buffer_load_dwordx4 v57, s[56:59], s96 offen nt lds
    s_add_u32 s96, s96, 32768
    s_add_u32 m0, m0, 0x400
    s_lshl_b32 s90, s3, 13
    s_add_u32 m0, s90, 118784
    s_nop 0
    buffer_load_dwordx4 v56, s[56:59], s97 offen nt lds
    s_add_u32 s97, s97, 32768
    s_add_u32 m0, m0, 0x400
    s_nop 0
    buffer_load_dwordx4 v56, s[56:59], s97 offen nt lds
    s_add_u32 s97, s97, 32768
    s_add_u32 m0, m0, 0x400
    s_nop 0
    buffer_load_dwordx4 v57, s[56:59], s97 offen nt lds
    s_add_u32 s97, s97, 32768
    s_add_u32 m0, m0, 0x400
    s_nop 0
    buffer_load_dwordx4 v57, s[56:59], s97 offen nt lds
    s_add_u32 s97, s97, 32768
    s_add_u32 m0, m0, 0x400
    s_nop 0
    buffer_load_dwordx4 v56, s[56:59], s97 offen nt lds
    s_add_u32 s97, s97, 32768
    s_add_u32 m0, m0, 0x400
    s_nop 0
    buffer_load_dwordx4 v56, s[56:59], s97 offen nt lds
    s_add_u32 s97, s97, 32768
    s_add_u32 m0, m0, 0x400
    s_nop 0
    buffer_load_dwordx4 v57, s[56:59], s97 offen nt lds
    s_add_u32 s97, s97, 32768
    s_add_u32 m0, m0, 0x400
    s_nop 0
    buffer_load_dwordx4 v57, s[56:59], s97 offen nt lds
    s_add_u32 s97, s97, 32768
    s_add_u32 m0, m0, 0x400
L_m_nowq:
    v_bfe_u32 v6, v2, 2, 1
    v_mul_u32_u24 v6, 272, v6
    v_lshl_add_u32 v6, v1, 4, v6
    v_bfe_u32 v16, v0, 2, 2
    v_and_b32 v17, 3, v0
    v_lshl_add_u32 v18, v1, 3, v16
    v_lshrrev_b32 v19, 1, v17
    v_and_b32 v20, 1, v17
    v_and_b32 v21, 1, v1
    v_lshrrev_b32 v22, 1, v16
    v_lshl_or_b32 v22, v21, 1, v22
    v_lshlrev_b32 v22, 1, v22
    s_lshl_b32 s90, s3, 1
    v_add_u32 v23, s90, v19
    v_xor_b32 v23, v23, v22
    v_lshlrev_b32 v7, 7, v18
    v_lshl_add_u32 v7, v23, 4, v7
    v_lshl_add_u32 v7, v20, 3, v7
    s_and_b32 s90, s3, 1
    s_lshl_b32 s90, s90, 1
    v_add_u32 v23, s90, v19
    v_lshlrev_b32 v22, 1, v21
    v_xor_b32 v23, v23, v22
    v_lshlrev_b32 v12, 6, v18
    v_lshl_add_u32 v12, v23, 4, v12
    v_lshl_add_u32 v12, v20, 3, v12
    v_lshl_or_b32 v22, v21, 2, v16
    v_lshlrev_b32 v22, 1, v22
    s_lshl_b32 s90, s3, 2
    v_add_u32 v23, s90, v19
    v_xor_b32 v24, v23, v22
    v_lshlrev_b32 v25, 8, v18
    v_lshl_add_u32 v25, v20, 3, v25
    v_lshl_add_u32 v13, v24, 4, v25
    v_add_u32 v23, 2, v23
    v_xor_b32 v24, v23, v22
    v_lshl_add_u32 v14, v24, 4, v25
    v_bfe_u32 v8, v0, 4, 1
    v_lshlrev_b32 v9, 3, v2
    s_mul_i32 s25, s6, -32
    s_add_u32 s25, s25, 72
    s_mul_i32 s26, s6, -64
    s_add_u32 s26, s26, 144
    s_lshl_b32 s18, s4, 16
    s_lshl_b32 s94, s86, 13
    s_add_u32 s18, s18, s94
    s_lshl_b32 s94, s87, 9
    s_add_u32 s18, s18, s94
    s_lshl_b32 s94, s3, 7
    s_add_u32 s18, s18, s94
    s_add_u32 s18, s18, 589824
    s_lshl_b32 s19, s9, 14
    s_lshl_b32 s94, s3, 12
    s_add_u32 s19, s19, s94
    s_lshl_b32 s94, s4, 8
    s_add_u32 s19, s19, s94
    s_lshl_b32 s94, s8, 6
    s_add_u32 s19, s19, s94
    s_add_u32 s19, s19, 1114112
    s_add_u32 s21, s19, 589824
    s_lshr_b32 s90, s3, 1
    s_and_b32 s91, s3, 1
    s_lshl_b32 s20, s4, 15
    s_lshl_b32 s94, s90, 14
    s_add_u32 s20, s20, s94
    s_lshl_b32 s94, s8, 11
    s_add_u32 s20, s20, s94
    s_lshl_b32 s94, s9, 8
    s_add_u32 s20, s20, s94
    s_lshl_b32 s94, s91, 7
    s_add_u32 s20, s20, s94
    s_add_u32 s20, s20, 1441792
    s_lshl_b32 s24, s4, 11
    s_lshl_b32 s94, s86, 10
    s_add_u32 s24, s24, s94
    s_lshl_b32 s94, s87, 4
    s_add_u32 s24, s24, s94
    s_add_u32 s24, s24, 524288
    s_and_b32 s90, s7, 1
    s_lshl_b32 s90, s90, 1
    s_lshr_b32 s91, s3, 1
    s_add_u32 s90, s90, s91
    s_lshr_b32 s91, s7, 1
    s_and_b32 s97, s3, 1
    s_lshl_b32 s17, s4, 15
    s_lshl_b32 s94, s90, 12
    s_add_u32 s17, s17, s94
    s_lshl_b32 s94, s91, 10
    s_add_u32 s17, s17, s94
    s_lshl_b32 s94, s97, 9
    s_add_u32 s17, s17, s94
    s_add_u32 s17, s17, 262144
    s_cmp_lt_u32 s7, 16
    s_cbranch_scc1 L_m_offA
    s_lshr_b32 s90, s4, 2
    s_and_b32 s91, s4, 3
    s_bfe_u32 s97, s7, 0x10002
    s_and_b32 s98, s7, 3
    s_lshl_b32 s16, s90, 15
    s_lshl_b32 s94, s91, 12
    s_add_u32 s16, s16, s94
    s_lshl_b32 s94, s98, 10
    s_add_u32 s16, s16, s94
    s_lshl_b32 s94, s97, 9
    s_add_u32 s16, s16, s94
    s_lshl_b32 s94, s3, 7
    s_add_u32 s16, s16, s94
    s_add_u32 s16, s16, 4096
    s_branch L_m_offE
L_m_offA:
    s_lshr_b32 s90, s4, 1
    s_and_b32 s91, s4, 1
    s_lshl_b32 s91, s91, 2
    s_lshr_b32 s97, s7, 2
    s_add_u32 s91, s91, s97
    s_lshr_b32 s97, s91, 1
    s_and_b32 s91, s91, 1
    s_and_b32 s98, s7, 3
    s_lshl_b32 s16, s90, 15
    s_lshl_b32 s94, s97, 12
    s_add_u32 s16, s16, s94
    s_lshl_b32 s94, s98, 10
    s_add_u32 s16, s16, s94
    s_lshl_b32 s94, s91, 9
    s_add_u32 s16, s16, s94
    s_lshl_b32 s94, s3, 7
    s_add_u32 s16, s16, s94
    s_add_u32 s16, s16, 69632
L_m_offE:
    s_waitcnt vmcnt(0)
    v_readfirstlane_b32 s89, v3
    s_nop 0
    s_add_u32 s89, s89, 1
    s_mul_i32 s10, s89, 0x9E3779B1
    v_mov_b32 v3, 0
    s_cmp_lg_u32 s6, 0
    s_cbranch_scc1 L_m_B
Lsp_13:
    ds_read_b32 v5, v3 offset:4
    s_waitcnt lgkmcnt(0)
    v_readfirstlane_b32 s91, v5
    s_nop 0
    s_cmp_ge_i32 s91, 2
    s_cbranch_scc1 Lspe_14
    s_sub_u32 s11, s11, 1
    s_cbranch_scc1 L_abort
    s_sleep 1
    s_branch Lsp_13
Lspe_14:
Lsp_15:
    ds_read_b32 v5, v3 offset:76
    s_waitcnt lgkmcnt(0)
    v_readfirstlane_b32 s91, v5
    s_nop 0
    s_cmp_ge_i32 s91, 1
    s_cbranch_scc1 Lspe_16
    s_sub_u32 s11, s11, 1
    s_cbranch_scc1 L_abort
    s_sleep 1
    s_branch Lsp_15
Lspe_16:
    v_add_u32 v10, 143360, v7
    ds_read_b64_tr_b16 v[16:17], v10 offset:0
    ds_read_b64_tr_b16 v[18:19], v10 offset:512
    ds_read_b64_tr_b16 v[20:21], v10 offset:4096
    ds_read_b64_tr_b16 v[22:23], v10 offset:4608
    ds_read_b64_tr_b16 v[24:25], v10 offset:8192
    ds_read_b64_tr_b16 v[26:27], v10 offset:8704
    ds_read_b64_tr_b16 v[28:29], v10 offset:12288
    ds_read_b64_tr_b16 v[30:31], v10 offset:12800
    ds_read_b128 v[32:35], v6 offset:768
    ds_read_b128 v[36:39], v6 offset:832
    ds_read_b128 v[40:43], v6 offset:896
    ds_read_b128 v[44:47], v6 offset:960
    s_waitcnt lgkmcnt(3)
    v_mfma_f32_16x16x32_bf16 v[48:51], v[32:35], v[16:19], 0
    s_waitcnt lgkmcnt(2)
    v_mfma_f32_16x16x32_bf16 v[48:51], v[36:39], v[20:23], v[48:51]
    s_waitcnt lgkmcnt(1)
    v_mfma_f32_16x16x32_bf16 v[48:51], v[40:43], v[24:27], v[48:51]
    s_waitcnt lgkmcnt(0)
    v_mfma_f32_16x16x32_bf16 v[48:51], v[44:47], v[28:31], v[48:51]
    s_mov_b64 s[92:93], exec
    s_mov_b64 exec, 1
    ds_add_u32 v3, v4 offset:16
    s_mov_b64 exec, s[92:93]
    v_lshl_add_u32 v54, v8, 14, v9
    v_mov_b32 v53, s10
    s_nop 1
    v_mov_b32 v52, v48
    s_mov_b32 exec_hi, 0
    buffer_store_dwordx2 v[52:53], v54, s[12:15], s16 offen sc1
    s_mov_b32 exec_hi, -1
    s_mov_b64 s[92:93], exec
    s_mov_b64 exec, 1
    ds_add_u32 v3, v4 offset:56
    s_mov_b64 exec, s[92:93]
    s_branch L_m_s3
L_m_B:
    s_waitcnt vmcnt(0)
    s_mov_b64 s[92:93], exec
    s_mov_b64 exec, 1
    ds_add_u32 v3, v4 offset:68
    s_mov_b64 exec, s[92:93]
    v_bfe_u32 v16, v0, 2, 2
    v_and_b32 v17, 3, v0
    v_lshl_add_u32 v18, v1, 3, v16
    v_lshrrev_b32 v19, 1, v17
    v_and_b32 v20, 1, v17
    v_and_b32 v21, 1, v1
    v_lshl_or_b32 v22, v21, 2, v16
    v_lshlrev_b32 v22, 1, v22
    v_lshlrev_b32 v25, 8, v18
    v_lshl_add_u32 v25, v20, 3, v25
    s_lshr_b32 s90, s3, 1
    s_lshl_b32 s90, s90, 15
    s_add_u32 s90, s90, 86016
    v_add_u32 v25, s90, v25
    s_and_b32 s91, s3, 1
    s_lshl_b32 s91, s91, 3
    v_add_u32 v19, s91, v19
    v_add_u32 v23, 0, v19
    v_xor_b32 v23, v23, v22
    v_lshl_add_u32 v28, v23, 4, v25
    v_add_u32 v23, 2, v19
    v_xor_b32 v23, v23, v22
    v_lshl_add_u32 v29, v23, 4, v25
    v_add_u32 v23, 4, v19
    v_xor_b32 v23, v23, v22
    v_lshl_add_u32 v30, v23, 4, v25
    v_add_u32 v23, 6, v19
    v_xor_b32 v23, v23, v22
    v_lshl_add_u32 v31, v23, 4, v25
Lsp_17:
    ds_read_b32 v5, v3 offset:68
    s_waitcnt lgkmcnt(0)
    v_readfirstlane_b32 s91, v5
    s_nop 0
    s_cmp_ge_i32 s91, 4
    s_cbranch_scc1 Lspe_18
    s_sub_u32 s11, s11, 1
    s_cbranch_scc1 L_abort
    s_branch Lsp_17
Lspe_18:
    ds_read_b64_tr_b16 v[64:65], v28 offset:0
    ds_read_b64_tr_b16 v[66:67], v28 offset:1024
    ds_read_b64_tr_b16 v[68:69], v28 offset:8192
    ds_read_b64_tr_b16 v[70:71], v28 offset:9216
    ds_read_b64_tr_b16 v[72:73], v28 offset:16384
    ds_read_b64_tr_b16 v[74:75], v28 offset:17408
    ds_read_b64_tr_b16 v[76:77], v28 offset:24576
    ds_read_b64_tr_b16 v[78:79], v28 offset:25600
    ds_read_b64_tr_b16 v[80:81], v29 offset:0
    ds_read_b64_tr_b16 v[82:83], v29 offset:1024
    ds_read_b64_tr_b16 v[84:85], v29 offset:8192
    ds_read_b64_tr_b16 v[86:87], v29 offset:9216
    ds_read_b64_tr_b16 v[88:89], v29 offset:16384
    ds_read_b64_tr_b16 v[90:91], v29 offset:17408
    ds_read_b64_tr_b16 v[92:93], v29 offset:24576
    ds_read_b64_tr_b16 v[94:95], v29 offset:25600
    ds_read_b64_tr_b16 v[96:97], v30 offset:0
    ds_read_b64_tr_b16 v[98:99], v30 offset:1024
    ds_read_b64_tr_b16 v[100:101], v30 offset:8192
    ds_read_b64_tr_b16 v[102:103], v30 offset:9216
    ds_read_b64_tr_b16 v[104:105], v30 offset:16384
    ds_read_b64_tr_b16 v[106:107], v30 offset:17408
    ds_read_b64_tr_b16 v[108:109], v30 offset:24576
    ds_read_b64_tr_b16 v[110:111], v30 offset:25600
    ds_read_b64_tr_b16 v[112:113], v31 offset:0
    ds_read_b64_tr_b16 v[114:115], v31 offset:1024
    ds_read_b64_tr_b16 v[116:117], v31 offset:8192
    ds_read_b64_tr_b16 v[118:119], v31 offset:9216
    ds_read_b64_tr_b16 v[120:121], v31 offset:16384
    ds_read_b64_tr_b16 v[122:123], v31 offset:17408
    ds_read_b64_tr_b16 v[124:125], v31 offset:24576
    ds_read_b64_tr_b16 v[126:127], v31 offset:25600
Lsp_19:
    ds_read_b32 v5, v3 offset:80
    s_waitcnt lgkmcnt(0)
    v_readfirstlane_b32 s91, v5
    s_nop 0
    s_cmp_ge_i32 s91, 1
    s_cbranch_scc1 Lspe_20
    s_sub_u32 s11, s11, 1
    s_cbranch_scc1 L_abort
    s_sleep 1
    s_branch Lsp_19
Lspe_20:
    s_mov_b32 s88, s91
    s_waitcnt lgkmcnt(0)
    s_mov_b64 s[92:93], exec
    s_mov_b64 exec, 1
    ds_add_u32 v3, v4 offset:16
    s_mov_b64 exec, s[92:93]
    v_lshl_add_u32 v54, v8, 14, v9
    v_mov_b32 v53, s10
Lsp_21:
    ds_read_b32 v5, v3 offset:8
    s_waitcnt lgkmcnt(0)
    v_readfirstlane_b32 s91, v5
    s_nop 0
    s_cmp_ge_i32 s91, 2
    s_cbranch_scc1 Lspe_22
    s_sub_u32 s11, s11, 1
    s_cbranch_scc1 L_abort
    s_branch Lsp_21
Lspe_22:
    ds_read_b128 v[32:35], v6 offset:1344
    ds_read_b128 v[36:39], v6 offset:1408
    ds_read_b128 v[40:43], v6 offset:1472
    ds_read_b128 v[44:47], v6 offset:1536
    s_waitcnt lgkmcnt(3)
    v_mfma_f32_16x16x32_bf16 v[16:19], v[32:35], v[64:67], 0
    v_mfma_f32_16x16x32_bf16 v[20:23], v[32:35], v[80:83], 0
    v_mfma_f32_16x16x32_bf16 v[24:27], v[32:35], v[96:99], 0
    v_mfma_f32_16x16x32_bf16 v[28:31], v[32:35], v[112:115], 0
    s_waitcnt lgkmcnt(2)
    v_mfma_f32_16x16x32_bf16 v[16:19], v[36:39], v[68:71], v[16:19]
    v_mfma_f32_16x16x32_bf16 v[20:23], v[36:39], v[84:87], v[20:23]
    v_mfma_f32_16x16x32_bf16 v[24:27], v[36:39], v[100:103], v[24:27]
    v_mfma_f32_16x16x32_bf16 v[28:31], v[36:39], v[116:119], v[28:31]
    s_waitcnt lgkmcnt(1)
    v_mfma_f32_16x16x32_bf16 v[16:19], v[40:43], v[72:75], v[16:19]
    v_mfma_f32_16x16x32_bf16 v[20:23], v[40:43], v[88:91], v[20:23]
    v_mfma_f32_16x16x32_bf16 v[24:27], v[40:43], v[104:107], v[24:27]
    v_mfma_f32_16x16x32_bf16 v[28:31], v[40:43], v[120:123], v[28:31]
    s_waitcnt lgkmcnt(0)
    v_mfma_f32_16x16x32_bf16 v[16:19], v[44:47], v[76:79], v[16:19]
    v_mfma_f32_16x16x32_bf16 v[20:23], v[44:47], v[92:95], v[20:23]
    v_mfma_f32_16x16x32_bf16 v[24:27], v[44:47], v[108:111], v[24:27]
    v_mfma_f32_16x16x32_bf16 v[28:31], v[44:47], v[124:127], v[28:31]
    s_mov_b32 exec_hi, 0
    s_nop 3
    v_mov_b32 v56, v16
    v_mov_b32 v57, v53
    v_mov_b32 v58, v20
    v_mov_b32 v59, v53
    v_mov_b32 v60, v24
    v_mov_b32 v61, v53
    v_mov_b32 v62, v28
    v_mov_b32 v63, v53
    s_cmp_eq_u32 s88, 1
    s_cbranch_scc1 Lst_23
    buffer_store_dwordx2 v[56:57], v54, s[12:15], s17 offen offset:0 sc1
    buffer_store_dwordx2 v[58:59], v54, s[12:15], s17 offen offset:128 sc1
    buffer_store_dwordx2 v[60:61], v54, s[12:15], s17 offen offset:256 sc1
    buffer_store_dwordx2 v[62:63], v54, s[12:15], s17 offen offset:384 sc1
    s_branch Lste_24
Lst_23:
    buffer_store_dwordx2 v[56:57], v54, s[12:15], s17 offen offset:0
    buffer_store_dwordx2 v[58:59], v54, s[12:15], s17 offen offset:128
    buffer_store_dwordx2 v[60:61], v54, s[12:15], s17 offen offset:256
    buffer_store_dwordx2 v[62:63], v54, s[12:15], s17 offen offset:384
Lste_24:
    s_mov_b32 exec_hi, -1
    s_mov_b64 s[92:93], exec
    s_mov_b64 exec, 1
    ds_add_u32 v3, v4 offset:60
    s_mov_b64 exec, s[92:93]
L_m_s3:
Lsp_25:
    ds_read_b32 v5, v3 offset:80
    s_waitcnt lgkmcnt(0)
    v_readfirstlane_b32 s91, v5
    s_nop 0
    s_cmp_ge_i32 s91, 1
    s_cbranch_scc1 Lspe_26
    s_sub_u32 s11, s11, 1
    s_cbranch_scc1 L_abort
    s_sleep 1
    s_branch Lsp_25
Lspe_26:
    s_mov_b32 s88, s91
    s_lshl_b32 s90, s6, 1
    s_sub_u32 s90, 4, s90
    s_mul_i32 s27, s3, s90
    s_min_u32 s91, s3, 2
    s_add_u32 s27, s27, s91
    s_cmp_lt_u32 s3, 2
    s_addc_u32 s28, s90, 0
    s_mov_b64 s[30:31], -1
    s_cmp_eq_u32 s28, 3
    s_cselect_b32 s31, 0xffff, s31
    s_cmp_eq_u32 s28, 2
    s_cselect_b32 s31, 0, s31
    s_mov_b32 s33, 0
    s_cmp_eq_u32 s28, 5
    s_cselect_b32 s32, 0xffff, 0
    v_xor_b32 v10, v1, v2
    v_lshlrev_b32 v10, 4, v10
    v_lshl_add_u32 v10, v2, 8, v10
    s_lshl_b32 s90, s27, 12
    s_add_u32 s90, s90, 12288
    v_add_u32 v112, s90, v10
    v_xor_b32 v113, 64, v112
    v_xor_b32 v114, 0x80, v112
    v_xor_b32 v115, 0xc0, v112
    v_and_b32 v10, 3, v2
    v_mul_u32_u24 v10, 272, v10
    v_lshl_add_u32 v116, v1, 4, v10
    v_cmp_eq_u32 s[34:35], 1, v1
    v_cmp_eq_u32 s[36:37], 2, v1
    v_cmp_eq_u32 s[38:39], 3, v1
    v_mov_b32 v80, 0
    v_mov_b32 v81, 0
    v_mov_b32 v82, 0
    v_mov_b32 v83, 0
    v_mov_b32 v84, 0
    v_mov_b32 v85, 0
    v_mov_b32 v86, 0
    v_mov_b32 v87, 0
    v_mov_b32 v88, 0
    v_mov_b32 v89, 0
    v_mov_b32 v90, 0
    v_mov_b32 v91, 0
    v_mov_b32 v92, 0
    v_mov_b32 v93, 0
    v_mov_b32 v94, 0
    v_mov_b32 v95, 0
    v_mov_b32 v96, 0
    v_mov_b32 v97, 0
    v_mov_b32 v98, 0
    v_mov_b32 v99, 0
    s_mov_b32 s29, 0xff800000
Lsp_27:
    ds_read_b32 v5, v3 offset:12
    s_waitcnt lgkmcnt(0)
    v_readfirstlane_b32 s91, v5
    s_nop 0
    s_cmp_ge_i32 s91, 2
    s_cbranch_scc1 Lspe_28
    s_sub_u32 s11, s11, 1
    s_cbranch_scc1 L_abort
    s_branch Lsp_27
Lspe_28:
Lsp_29:
    ds_read_b32 v5, v3 offset:0
    s_waitcnt lgkmcnt(0)
    v_readfirstlane_b32 s91, v5
    s_nop 0
    s_cmp_ge_i32 s91, s25
    s_cbranch_scc1 Lspe_30
    s_sub_u32 s11, s11, 1
    s_cbranch_scc1 L_abort
    s_branch Lsp_29
Lspe_30:
    ds_read_b128 v[16:19], v116 offset:3648
    ds_read_b128 v[20:23], v116 offset:3712
    ds_read_b128 v[24:27], v116 offset:3776
    ds_read_b128 v[28:31], v116 offset:3840
    ds_read_b128 v[32:35], v112 offset:0
    ds_read_b128 v[36:39], v113 offset:0
    ds_read_b128 v[40:43], v114 offset:0
    ds_read_b128 v[44:47], v115 offset:0
    ds_read_b128 v[48:51], v112 offset:4096
    ds_read_b128 v[52:55], v113 offset:4096
    ds_read_b128 v[56:59], v114 offset:4096
    ds_read_b128 v[60:63], v115 offset:4096
    s_cmp_eq_u32 s28, 2
    s_cbranch_scc1 L_qk_n2
    ds_read_b128 v[64:67], v112 offset:8192
    ds_read_b128 v[68:71], v113 offset:8192
    ds_read_b128 v[72:75], v114 offset:8192
    ds_read_b128 v[76:79], v115 offset:8192
    s_waitcnt lgkmcnt(8)
    v_mfma_f32_16x16x32_bf16 v[80:83], v[16:19], v[32:35], 0
    v_mfma_f32_16x16x32_bf16 v[80:83], v[20:23], v[36:39], v[80:83]
    v_mfma_f32_16x16x32_bf16 v[80:83], v[24:27], v[40:43], v[80:83]
    v_mfma_f32_16x16x32_bf16 v[80:83], v[28:31], v[44:47], v[80:83]
    s_cmp_eq_u32 s28, 3
    s_cbranch_scc1 L_qk_n3
    ds_read_b128 v[32:35], v112 offset:12288
    ds_read_b128 v[36:39], v113 offset:12288
    ds_read_b128 v[40:43], v114 offset:12288
    ds_read_b128 v[44:47], v115 offset:12288
    s_waitcnt lgkmcnt(8)
    v_mfma_f32_16x16x32_bf16 v[84:87], v[16:19], v[48:51], 0
    v_mfma_f32_16x16x32_bf16 v[84:87], v[20:23], v[52:55], v[84:87]
    v_mfma_f32_16x16x32_bf16 v[84:87], v[24:27], v[56:59], v[84:87]
    v_mfma_f32_16x16x32_bf16 v[84:87], v[28:31], v[60:63], v[84:87]
    s_cmp_eq_u32 s28, 4
    s_cbranch_scc1 L_qk_n4
    ds_read_b128 v[48:51], v112 offset:16384
    ds_read_b128 v[52:55], v113 offset:16384
    ds_read_b128 v[56:59], v114 offset:16384
    ds_read_b128 v[60:63], v115 offset:16384
    s_waitcnt lgkmcnt(8)
    v_mfma_f32_16x16x32_bf16 v[88:91], v[16:19], v[64:67], 0
    v_mfma_f32_16x16x32_bf16 v[88:91], v[20:23], v[68:71], v[88:91]
    v_mfma_f32_16x16x32_bf16 v[88:91], v[24:27], v[72:75], v[88:91]
    v_mfma_f32_16x16x32_bf16 v[88:91], v[28:31], v[76:79], v[88:91]
    s_waitcnt lgkmcnt(4)
    v_mfma_f32_16x16x32_bf16 v[92:95], v[16:19], v[32:35], 0
    v_mfma_f32_16x16x32_bf16 v[92:95], v[20:23], v[36:39], v[92:95]
    v_mfma_f32_16x16x32_bf16 v[92:95], v[24:27], v[40:43], v[92:95]
    v_mfma_f32_16x16x32_bf16 v[92:95], v[28:31], v[44:47], v[92:95]
    s_waitcnt lgkmcnt(0)
    v_mfma_f32_16x16x32_bf16 v[96:99], v[16:19], v[48:51], 0
    v_mfma_f32_16x16x32_bf16 v[96:99], v[20:23], v[52:55], v[96:99]
    v_mfma_f32_16x16x32_bf16 v[96:99], v[24:27], v[56:59], v[96:99]
    v_mfma_f32_16x16x32_bf16 v[96:99], v[28:31], v[60:63], v[96:99]
    s_branch L_qk_done
L_qk_n4:
    s_waitcnt lgkmcnt(4)
    v_mfma_f32_16x16x32_bf16 v[88:91], v[16:19], v[64:67], 0
    v_mfma_f32_16x16x32_bf16 v[88:91], v[20:23], v[68:71], v[88:91]
    v_mfma_f32_16x16x32_bf16 v[88:91], v[24:27], v[72:75], v[88:91]
    v_mfma_f32_16x16x32_bf16 v[88:91], v[28:31], v[76:79], v[88:91]
    s_waitcnt lgkmcnt(0)
    v_mfma_f32_16x16x32_bf16 v[92:95], v[16:19], v[32:35], 0
    v_mfma_f32_16x16x32_bf16 v[92:95], v[20:23], v[36:39], v[92:95]
    v_mfma_f32_16x16x32_bf16 v[92:95], v[24:27], v[40:43], v[92:95]
    v_mfma_f32_16x16x32_bf16 v[92:95], v[28:31], v[44:47], v[92:95]
    s_branch L_qk_done
L_qk_n3:
    s_waitcnt lgkmcnt(4)
    v_mfma_f32_16x16x32_bf16 v[84:87], v[16:19], v[48:51], 0
    v_mfma_f32_16x16x32_bf16 v[84:87], v[20:23], v[52:55], v[84:87]
    v_mfma_f32_16x16x32_bf16 v[84:87], v[24:27], v[56:59], v[84:87]
    v_mfma_f32_16x16x32_bf16 v[84:87], v[28:31], v[60:63], v[84:87]
    s_waitcnt lgkmcnt(0)
    v_mfma_f32_16x16x32_bf16 v[88:91], v[16:19], v[64:67], 0
    v_mfma_f32_16x16x32_bf16 v[88:91], v[20:23], v[68:71], v[88:91]
    v_mfma_f32_16x16x32_bf16 v[88:91], v[24:27], v[72:75], v[88:91]
    v_mfma_f32_16x16x32_bf16 v[88:91], v[28:31], v[76:79], v[88:91]
    s_branch L_qk_done
L_qk_n2:
    s_waitcnt lgkmcnt(4)
    v_mfma_f32_16x16x32_bf16 v[80:83], v[16:19], v[32:35], 0
    v_mfma_f32_16x16x32_bf16 v[80:83], v[20:23], v[36:39], v[80:83]
    v_mfma_f32_16x16x32_bf16 v[80:83], v[24:27], v[40:43], v[80:83]
    v_mfma_f32_16x16x32_bf16 v[80:83], v[28:31], v[44:47], v[80:83]
    s_waitcnt lgkmcnt(0)
    v_mfma_f32_16x16x32_bf16 v[84:87], v[16:19], v[48:51], 0
    v_mfma_f32_16x16x32_bf16 v[84:87], v[20:23], v[52:55], v[84:87]
    v_mfma_f32_16x16x32_bf16 v[84:87], v[24:27], v[56:59], v[84:87]
    v_mfma_f32_16x16x32_bf16 v[84:87], v[28:31], v[60:63], v[84:87]
L_qk_done:
    s_mov_b64 s[92:93], exec
    s_mov_b64 exec, 1
    ds_add_u32 v3, v4 offset:20
    s_mov_b64 exec, s[92:93]
    s_nop 7
    v_cndmask_b32 v48, v80, v84, s[34:35]
    v_cndmask_b32 v49, v81, v85, s[34:35]
    v_cndmask_b32 v50, v82, v86, s[34:35]
    v_cndmask_b32 v51, v83, v87, s[34:35]
    v_cndmask_b32 v48, v48, v88, s[36:37]
    v_cndmask_b32 v49, v49, v89, s[36:37]
    v_cndmask_b32 v50, v50, v90, s[36:37]
    v_cndmask_b32 v51, v51, v91, s[36:37]
    v_cndmask_b32 v48, v48, v92, s[38:39]
    v_cndmask_b32 v49, v49, v93, s[38:39]
    v_cndmask_b32 v50, v50, v94, s[38:39]
    v_cndmask_b32 v51, v51, v95, s[38:39]
    s_mov_b32 s94, 0x3db504f3
    v_cvt_pk_bf16_f32 v32, v96, v97
    v_lshlrev_b32 v20, 16, v32
    v_and_b32 v21, 0xffff0000, v32
    v_cvt_pk_bf16_f32 v33, v98, v99
    v_lshlrev_b32 v22, 16, v33
    v_and_b32 v23, 0xffff0000, v33
    v_cvt_pk_bf16_f32 v32, v48, v49
    v_lshlrev_b32 v16, 16, v32
    v_and_b32 v17, 0xffff0000, v32
    v_cvt_pk_bf16_f32 v33, v50, v51
    v_lshlrev_b32 v18, 16, v33
    v_and_b32 v19, 0xffff0000, v33
    v_mul_f32 v16, s94, v16
    v_mul_f32 v17, s94, v17
    v_mul_f32 v18, s94, v18
    v_mul_f32 v19, s94, v19
    v_mul_f32 v20, s94, v20
    v_mul_f32 v21, s94, v21
    v_mul_f32 v22, s94, v22
    v_mul_f32 v23, s94, v23
    v_cvt_pk_bf16_f32 v32, v16, v17
    v_lshlrev_b32 v16, 16, v32
    v_and_b32 v17, 0xffff0000, v32
    v_cvt_pk_bf16_f32 v33, v18, v19
    v_lshlrev_b32 v18, 16, v33
    v_and_b32 v19, 0xffff0000, v33
    v_cvt_pk_bf16_f32 v32, v20, v21
    v_lshlrev_b32 v20, 16, v32
    v_and_b32 v21, 0xffff0000, v32
    v_cvt_pk_bf16_f32 v33, v22, v23
    v_lshlrev_b32 v22, 16, v33
    v_and_b32 v23, 0xffff0000, v33
    v_mov_b32 v34, s29
    v_cndmask_b32 v16, v34, v16, s[30:31]
    v_cndmask_b32 v17, v34, v17, s[30:31]
    v_cndmask_b32 v18, v34, v18, s[30:31]
    v_cndmask_b32 v19, v34, v19, s[30:31]
    v_cndmask_b32 v20, v34, v20, s[32:33]
    v_cndmask_b32 v21, v34, v21, s[32:33]
    v_cndmask_b32 v22, v34, v22, s[32:33]
    v_cndmask_b32 v23, v34, v23, s[32:33]
    v_max_f32 v24, v16, v20
    v_max_f32 v25, v17, v21
    v_max_f32 v26, v18, v22
    v_max_f32 v27, v19, v23
    v_max_f32_dpp v24, v24, v24 quad_perm:[1,0,3,2] row_mask:0xf bank_mask:0xf
    v_max_f32_dpp v25, v25, v25 quad_perm:[1,0,3,2] row_mask:0xf bank_mask:0xf
    v_max_f32_dpp v26, v26, v26 quad_perm:[1,0,3,2] row_mask:0xf bank_mask:0xf
    v_max_f32_dpp v27, v27, v27 quad_perm:[1,0,3,2] row_mask:0xf bank_mask:0xf
    v_max_f32_dpp v24, v24, v24 quad_perm:[2,3,0,1] row_mask:0xf bank_mask:0xf
    v_max_f32_dpp v25, v25, v25 quad_perm:[2,3,0,1] row_mask:0xf bank_mask:0xf
    v_max_f32_dpp v26, v26, v26 quad_perm:[2,3,0,1] row_mask:0xf bank_mask:0xf
    v_max_f32_dpp v27, v27, v27 quad_perm:[2,3,0,1] row_mask:0xf bank_mask:0xf
    v_max_f32_dpp v24, v24, v24 row_half_mirror row_mask:0xf bank_mask:0xf
    v_max_f32_dpp v25, v25, v25 row_half_mirror row_mask:0xf bank_mask:0xf
    v_max_f32_dpp v26, v26, v26 row_half_mirror row_mask:0xf bank_mask:0xf
    v_max_f32_dpp v27, v27, v27 row_half_mirror row_mask:0xf bank_mask:0xf
    v_max_f32_dpp v24, v24, v24 row_mirror row_mask:0xf bank_mask:0xf
    v_max_f32_dpp v25, v25, v25 row_mirror row_mask:0xf bank_mask:0xf
    v_max_f32_dpp v26, v26, v26 row_mirror row_mask:0xf bank_mask:0xf
    v_max_f32_dpp v27, v27, v27 row_mirror row_mask:0xf bank_mask:0xf
    v_max_f32_dpp v24, v24, v24 row_bcast:15 row_mask:0xa bank_mask:0xf
    v_max_f32_dpp v25, v25, v25 row_bcast:15 row_mask:0xa bank_mask:0xf
    v_max_f32_dpp v26, v26, v26 row_bcast:15 row_mask:0xa bank_mask:0xf
    v_max_f32_dpp v27, v27, v27 row_bcast:15 row_mask:0xa bank_mask:0xf
    v_max_f32_dpp v24, v24, v24 row_bcast:31 row_mask:0xc bank_mask:0xf
    v_max_f32_dpp v25, v25, v25 row_bcast:31 row_mask:0xc bank_mask:0xf
    v_max_f32_dpp v26, v26, v26 row_bcast:31 row_mask:0xc bank_mask:0xf
    v_max_f32_dpp v27, v27, v27 row_bcast:31 row_mask:0xc bank_mask:0xf
    s_lshl_b32 s90, s3, 4
    v_mov_b32 v10, s90
    s_mov_b32 exec_lo, 0
    s_mov_b32 exec_hi, 0x80000000
    ds_write_b128 v10, v[24:27] offset:128
    ds_add_u32 v3, v4 offset:24
    s_mov_b64 exec, -1
    s_lshl_b32 s90, s27, 5
    s_add_u32 s90, s90, 4736
    v_lshl_add_u32 v10, v0, 1, s90
Lsp_31:
    ds_read_b32 v5, v3 offset:24
    s_waitcnt lgkmcnt(0)
    v_readfirstlane_b32 s91, v5
    s_nop 0
    s_cmp_ge_i32 s91, 4
    s_cbranch_scc1 Lspe_32
    s_sub_u32 s11, s11, 1
    s_cbranch_scc1 L_abort
    s_branch Lsp_31
Lspe_32:
    ds_read_b128 v[32:35], v3 offset:128
    ds_read_b128 v[36:39], v3 offset:144
    ds_read_b128 v[40:43], v3 offset:160
    ds_read_b128 v[44:47], v3 offset:176
    s_mov_b32 s94, 0x3fb8aa3b
    s_waitcnt lgkmcnt(0)
    v_max3_f32 v24, v32, v36, v40
    v_max3_f32 v25, v33, v37, v41
    v_max3_f32 v26, v34, v38, v42
    v_max3_f32 v27, v35, v39, v43
    v_max_f32 v24, v24, v44
    v_max_f32 v25, v25, v45
    v_max_f32 v26, v26, v46
    v_max_f32 v27, v27, v47
    v_sub_f32 v16, v16, v24
    v_sub_f32 v17, v17, v25
    v_sub_f32 v18, v18, v26
    v_sub_f32 v19, v19, v27
    v_sub_f32 v20, v20, v24
    v_sub_f32 v21, v21, v25
    v_sub_f32 v22, v22, v26
    v_sub_f32 v23, v23, v27
    v_mul_f32 v16, s94, v16
    v_mul_f32 v17, s94, v17
    v_mul_f32 v18, s94, v18
    v_mul_f32 v19, s94, v19
    v_mul_f32 v20, s94, v20
    v_mul_f32 v21, s94, v21
    v_mul_f32 v22, s94, v22
    v_mul_f32 v23, s94, v23
    v_exp_f32 v16, v16
    v_exp_f32 v17, v17
    v_exp_f32 v18, v18
    v_exp_f32 v19, v19
    v_exp_f32 v20, v20
    v_exp_f32 v21, v21
    v_exp_f32 v22, v22
    v_exp_f32 v23, v23
    v_cvt_pk_bf16_f32 v28, v16, v17
    v_cvt_pk_bf16_f32 v29, v18, v19
    v_cvt_pk_bf16_f32 v30, v20, v21
    v_cvt_pk_bf16_f32 v31, v22, v23
    s_mov_b64 exec, s[30:31]
    ds_write_b16 v10, v28
    ds_write_b16_d16_hi v10, v28 offset:592
    ds_write_b16 v10, v29 offset:1184
    ds_write_b16_d16_hi v10, v29 offset:1776
    s_cmp_lg_u32 s28, 5
    s_cbranch_scc1 L_p_w1
    s_mov_b64 exec, s[32:33]
    ds_write_b16 v10, v30 offset:128
    ds_write_b16_d16_hi v10, v30 offset:720
    ds_write_b16 v10, v31 offset:1312
    ds_write_b16_d16_hi v10, v31 offset:1904
L_p_w1:
    s_mov_b64 exec, 1
    ds_add_u32 v3, v4 offset:28
    s_mov_b64 exec, -1
L_m_pv:
    v_lshrrev_b32 v10, 2, v2
    v_mul_u32_u24 v10, 592, v10
    v_lshl_add_u32 v10, v1, 4, v10
    v_add_u32 v60, 4736, v10
    v_add_u32 v61, 86016, v13
    v_add_u32 v62, 86016, v14
    v_lshl_add_u32 v63, v1, 14, v9
    v_mov_b32 v65, s10
    v_mov_b32 v48, 0
    v_mov_b32 v49, 0
    v_mov_b32 v50, 0
    v_mov_b32 v51, 0
    v_mov_b32 v52, 0
    v_mov_b32 v53, 0
    v_mov_b32 v54, 0
    v_mov_b32 v55, 0
Lsp_33:
    ds_read_b32 v5, v3 offset:28
    s_waitcnt lgkmcnt(0)
    v_readfirstlane_b32 s91, v5
    s_nop 0
    s_cmp_ge_i32 s91, 4
    s_cbranch_scc1 Lspe_34
    s_sub_u32 s11, s11, 1
    s_cbranch_scc1 L_abort
    s_branch Lsp_33
Lspe_34:
    s_add_u32 s95, s25, 8
    s_mov_b32 s96, -1000
    s_cmp_ge_i32 s96, s95
    s_cbranch_scc1 L_pv_go0
L_pv_sp0:
    ds_read_b32 v5, v3 offset:0
    s_waitcnt lgkmcnt(0)
    v_readfirstlane_b32 s96, v5
    s_nop 0
    s_cmp_ge_i32 s96, s95
    s_cbranch_scc1 L_pv_go0
    s_sub_u32 s11, s11, 1
    s_cbranch_scc1 L_abort
    s_branch L_pv_sp0
L_pv_go0:
    ds_read_b128 v[16:19], v60
    ds_read_b64_tr_b16 v[20:21], v61
    ds_read_b64_tr_b16 v[22:23], v61 offset:1024
    ds_read_b64_tr_b16 v[24:25], v62
    ds_read_b64_tr_b16 v[26:27], v62 offset:1024
    v_add_u32 v60, 64, v60
    v_add_u32 v61, 0x2000, v61
    v_add_u32 v62, 0x2000, v62
    s_add_u32 s95, s95, 8
L_pv_loop:
    s_cmp_ge_i32 s96, s95
    s_cbranch_scc1 L_pv_go1
L_pv_sp1:
    ds_read_b32 v5, v3 offset:0
    s_waitcnt lgkmcnt(0)
    v_readfirstlane_b32 s96, v5
    s_nop 0
    s_cmp_ge_i32 s96, s95
    s_cbranch_scc1 L_pv_go1
    s_sub_u32 s11, s11, 1
    s_cbranch_scc1 L_abort
    s_branch L_pv_sp1
L_pv_go1:
    ds_read_b128 v[28:31], v60
    ds_read_b64_tr_b16 v[32:33], v61
    ds_read_b64_tr_b16 v[34:35], v61 offset:1024
    ds_read_b64_tr_b16 v[36:37], v62
    ds_read_b64_tr_b16 v[38:39], v62 offset:1024
    v_add_u32 v60, 64, v60
    v_add_u32 v61, 0x2000, v61
    v_add_u32 v62, 0x2000, v62
    s_add_u32 s95, s95, 8
    s_waitcnt lgkmcnt(5)
    v_mfma_f32_16x16x32_bf16 v[48:51], v[16:19], v[20:23], v[48:51]
    v_mfma_f32_16x16x32_bf16 v[52:55], v[16:19], v[24:27], v[52:55]
    s_cmp_ge_i32 s96, s95
    s_cbranch_scc1 L_pv_go2
L_pv_sp2:
    ds_read_b32 v5, v3 offset:0
    s_waitcnt lgkmcnt(0)
    v_readfirstlane_b32 s96, v5
    s_nop 0
    s_cmp_ge_i32 s96, s95
    s_cbranch_scc1 L_pv_go2
    s_sub_u32 s11, s11, 1
    s_cbranch_scc1 L_abort
    s_branch L_pv_sp2
L_pv_go2:
    ds_read_b128 v[16:19], v60
    ds_read_b64_tr_b16 v[20:21], v61
    ds_read_b64_tr_b16 v[22:23], v61 offset:1024
    ds_read_b64_tr_b16 v[24:25], v62
    ds_read_b64_tr_b16 v[26:27], v62 offset:1024
    v_add_u32 v60, 64, v60
    v_add_u32 v61, 0x2000, v61
    v_add_u32 v62, 0x2000, v62
    s_add_u32 s95, s95, 8
    s_waitcnt lgkmcnt(5)
    v_mfma_f32_16x16x32_bf16 v[48:51], v[28:31], v[32:35], v[48:51]
    v_mfma_f32_16x16x32_bf16 v[52:55], v[28:31], v[36:39], v[52:55]
    s_cmp_le_i32 s95, s26
    s_cbranch_scc1 L_pv_loop
    s_waitcnt lgkmcnt(0)
    v_mfma_f32_16x16x32_bf16 v[48:51], v[16:19], v[20:23], v[48:51]
    v_mfma_f32_16x16x32_bf16 v[52:55], v[16:19], v[24:27], v[52:55]
    s_nop 4
    s_nop 2
    v_cvt_pk_bf16_f32 v64, v48, v52
    s_cmp_eq_u32 s88, 1
    s_cbranch_scc1 Lst_35
    buffer_store_dwordx2 v[64:65], v63, s[12:15], s18 offen sc1
    s_branch Lste_36
Lst_35:
    buffer_store_dwordx2 v[64:65], v63, s[12:15], s18 offen
Lste_36:
    s_mov_b64 s[92:93], exec
    s_mov_b64 exec, 1
    ds_add_u32 v3, v4 offset:36
    s_mov_b64 exec, s[92:93]
Lsp_37:
    ds_read_b32 v5, v3 offset:72
    s_waitcnt lgkmcnt(0)
    v_readfirstlane_b32 s91, v5
    s_nop 0
    s_cmp_ge_i32 s91, 1
    s_cbranch_scc1 Lspe_38
    s_sub_u32 s11, s11, 1
    s_cbranch_scc1 L_abort
    s_branch Lsp_37
Lspe_38:
    s_mul_i32 s90, s6, 40960
    s_add_u32 s90, s90, 12288
    v_add_u32 v10, s90, v7
    ds_read_b64_tr_b16 v[16:17], v10 offset:0
    ds_read_b64_tr_b16 v[18:19], v10 offset:512
    ds_read_b64_tr_b16 v[20:21], v10 offset:4096
    ds_read_b64_tr_b16 v[22:23], v10 offset:4608
    ds_read_b64_tr_b16 v[24:25], v10 offset:8192
    ds_read_b64_tr_b16 v[26:27], v10 offset:8704
    ds_read_b64_tr_b16 v[28:29], v10 offset:12288
    ds_read_b64_tr_b16 v[30:31], v10 offset:12800
    s_waitcnt lgkmcnt(0)
    s_barrier
    ds_read_b128 v[32:35], v6 offset:1920
    ds_read_b128 v[36:39], v6 offset:1984
    ds_read_b128 v[40:43], v6 offset:2048
    ds_read_b128 v[44:47], v6 offset:2112
    s_waitcnt lgkmcnt(3)
    v_mfma_f32_16x16x32_bf16 v[48:51], v[32:35], v[16:19], 0
    s_waitcnt lgkmcnt(2)
    v_mfma_f32_16x16x32_bf16 v[48:51], v[36:39], v[20:23], v[48:51]
    s_waitcnt lgkmcnt(1)
    v_mfma_f32_16x16x32_bf16 v[48:51], v[40:43], v[24:27], v[48:51]
    s_waitcnt lgkmcnt(0)
    v_mfma_f32_16x16x32_bf16 v[48:51], v[44:47], v[28:31], v[48:51]
    v_lshlrev_b32 v54, 11, v8
    v_lshl_add_u32 v54, v2, 2, v54
    v_mov_b32 v53, s10
    s_nop 4
    v_mov_b32_dpp v52, v48 quad_perm:[1,0,3,2] row_mask:0xf bank_mask:0xf
    s_mov_b32 exec_lo, 0x55555555
    s_mov_b32 exec_hi, 0
    v_cvt_pk_bf16_f32 v52, v48, v52
    buffer_store_dwordx2 v[52:53], v54, s[12:15], s19 offen sc1
    s_mov_b64 exec, -1
    s_mov_b64 s[92:93], exec
    s_mov_b64 exec, 1
    ds_add_u32 v3, v4 offset:40
    s_mov_b64 exec, s[92:93]
Lsp_39:
    ds_read_b32 v5, v3 offset:32
    s_waitcnt lgkmcnt(0)
    v_readfirstlane_b32 s91, v5
    s_nop 0
    s_cmp_ge_i32 s91, 1
    s_cbranch_scc1 Lspe_40
    s_sub_u32 s11, s11, 1
    s_cbranch_scc1 L_abort
    s_sleep 1
    s_branch Lsp_39
Lspe_40:
    s_lshr_b32 s90, s3, 1
    s_lshl_b32 s90, s90, 13
    s_mul_i32 s91, s6, 0
    s_add_u32 s90, s90, s91
    s_add_u32 s90, s90, 28672
    v_add_u32 v11, s90, v12
    ds_read_b64_tr_b16 v[16:17], v11 offset:0
    ds_read_b64_tr_b16 v[18:19], v11 offset:256
    ds_read_b64_tr_b16 v[20:21], v11 offset:2048
    ds_read_b64_tr_b16 v[22:23], v11 offset:2304
    ds_read_b64_tr_b16 v[24:25], v11 offset:4096
    ds_read_b64_tr_b16 v[26:27], v11 offset:4352
    ds_read_b64_tr_b16 v[28:29], v11 offset:6144
    ds_read_b64_tr_b16 v[30:31], v11 offset:6400
    s_mul_i32 s90, s6, 106496
    s_add_u32 s90, s90, 45056
    v_add_u32 v15, s90, v7
    s_waitcnt lgkmcnt(0)
    s_barrier
    s_cmp_eq_u32 s9, 7
    s_cbranch_scc1 L_m_s7
    ds_read_b128 v[32:35], v6 offset:2496
    ds_read_b128 v[36:39], v6 offset:2560
    ds_read_b128 v[40:43], v6 offset:2624
    ds_read_b128 v[44:47], v6 offset:2688
    s_waitcnt lgkmcnt(3)
    v_mfma_f32_16x16x32_bf16 v[48:51], v[32:35], v[16:19], 0
    s_waitcnt lgkmcnt(2)
    v_mfma_f32_16x16x32_bf16 v[48:51], v[36:39], v[20:23], v[48:51]
    s_waitcnt lgkmcnt(1)
    v_mfma_f32_16x16x32_bf16 v[48:51], v[40:43], v[24:27], v[48:51]
    s_waitcnt lgkmcnt(0)
    v_mfma_f32_16x16x32_bf16 v[48:51], v[44:47], v[28:31], v[48:51]
    v_lshl_add_u32 v54, v8, 13, v9
    v_mov_b32 v53, s10
    s_nop 5
    v_mov_b32 v52, v48
    s_mov_b32 exec_hi, 0
    s_cmp_eq_u32 s88, 1
    s_cbranch_scc1 Lst_41
    buffer_store_dwordx2 v[52:53], v54, s[12:15], s20 offen sc1
    s_branch Lste_42
Lst_41:
    buffer_store_dwordx2 v[52:53], v54, s[12:15], s20 offen
Lste_42:
    s_mov_b32 exec_hi, -1
L_m_s7:
    s_mov_b64 s[92:93], exec
    s_mov_b64 exec, 1
    ds_add_u32 v3, v4 offset:48
    s_mov_b64 exec, s[92:93]
Lsp_43:
    ds_read_b32 v5, v3 offset:88
    s_waitcnt lgkmcnt(0)
    v_readfirstlane_b32 s91, v5
    s_nop 0
    s_cmp_ge_i32 s91, 1
    s_cbranch_scc1 Lspe_44
    s_sub_u32 s11, s11, 1
    s_cbranch_scc1 L_abort
    s_branch Lsp_43
Lspe_44:
    ds_read_b64_tr_b16 v[64:65], v15 offset:0
    ds_read_b64_tr_b16 v[66:67], v15 offset:512
    ds_read_b64_tr_b16 v[68:69], v15 offset:4096
    ds_read_b64_tr_b16 v[70:71], v15 offset:4608
    s_waitcnt lgkmcnt(0)
    s_barrier
    ds_read_b128 v[32:35], v6 offset:3072
    ds_read_b128 v[36:39], v6 offset:3136
    s_waitcnt lgkmcnt(1)
    v_mfma_f32_16x16x32_bf16 v[48:51], v[32:35], v[64:67], 0
    s_waitcnt lgkmcnt(0)
    v_mfma_f32_16x16x32_bf16 v[48:51], v[36:39], v[68:71], v[48:51]
    v_lshlrev_b32 v54, 11, v8
    v_lshl_add_u32 v54, v2, 2, v54
    v_mov_b32 v53, s10
    s_nop 4
    v_mov_b32_dpp v52, v48 quad_perm:[1,0,3,2] row_mask:0xf bank_mask:0xf
    s_mov_b32 exec_lo, 0x55555555
    s_mov_b32 exec_hi, 0
    v_cvt_pk_bf16_f32 v52, v48, v52
    buffer_store_dwordx2 v[52:53], v54, s[12:15], s21 offen sc1
    s_mov_b64 exec, -1
    s_mov_b64 s[92:93], exec
    s_mov_b64 exec, 1
    ds_add_u32 v3, v4 offset:52
    s_mov_b64 exec, s[92:93]
    s_endpgm
L_gwave:
    s_cmp_eq_u32 s3, 4
    s_cbranch_scc1 L_slice
    s_cmp_eq_u32 s3, 7
    s_cbranch_scc1 L_aux
    s_mov_b64 s[36:37], s[42:43]
    v_lshlrev_b32 v2, 2, v0
    v_mov_b32 v10, 1
    s_mul_i32 s98, s97, 272
    v_add_u32 v11, s98, v2
    v_mov_b32 v19, 0
    s_waitcnt vmcnt(0)
    v_lshlrev_b32 v12, 16, v9
    v_and_b32 v13, 0xffff0000, v9
    s_mov_b32 s94, 0x3fb8aa3b
    v_mul_f32 v14, s94, v12
    v_mul_f32 v15, s94, v13
    v_exp_f32 v14, -v14
    v_exp_f32 v15, -v15
    v_add_f32 v14, 1.0, v14
    v_add_f32 v15, 1.0, v15
    v_rcp_f32 v14, v14
    v_rcp_f32 v15, v15
    v_mul_f32 v12, v12, v14
    v_mul_f32 v13, v13, v15
    v_cvt_pk_bf16_f32 v12, v12, v13
    ds_write_b32 v11, v12 offset:768
    s_mov_b64 s[92:93], exec
    s_mov_b64 exec, 1
    ds_add_u32 v19, v10 offset:4
    s_mov_b64 exec, s[92:93]
    v_readfirstlane_b32 s89, v3
    s_nop 0
    s_add_u32 s89, s89, 1
    s_mul_i32 s10, s89, 0x9E3779B1
    v_mov_b32 v3, 0
    s_cmp_eq_u32 s6, 0
    s_cbranch_scc1 L_q_qg
    v_lshlrev_b32 v16, 16, v4
    v_and_b32 v17, 0xffff0000, v4
    v_lshlrev_b32 v18, 16, v5
    v_and_b32 v19, 0xffff0000, v5
    v_lshlrev_b32 v20, 16, v6
    v_and_b32 v21, 0xffff0000, v6
    v_lshlrev_b32 v22, 16, v7
    v_and_b32 v23, 0xffff0000, v7
    v_add_f32 v24, v16, v17
    v_add_f32 v25, v18, v19
    v_add_f32 v26, v20, v21
    v_add_f32 v27, v22, v23
    v_add_f32 v24, v24, v25
    v_add_f32 v26, v26, v27
    v_add_f32 v24, v24, v26
    s_nop 1
    v_add_f32_dpp v24, v24, v24 quad_perm:[1,0,3,2] row_mask:0xf bank_mask:0xf
    s_nop 1
    v_add_f32_dpp v24, v24, v24 quad_perm:[2,3,0,1] row_mask:0xf bank_mask:0xf
    s_nop 1
    v_add_f32_dpp v24, v24, v24 row_half_mirror row_mask:0xf bank_mask:0xf
    s_nop 1
    v_add_f32_dpp v24, v24, v24 row_mirror row_mask:0xf bank_mask:0xf
    v_mov_b32 v28, v24
    s_nop 1
    v_permlane16_swap_b32 v24, v28
    v_add_f32 v24, v24, v28
    v_mov_b32 v28, v24
    s_nop 1
    v_permlane32_swap_b32 v24, v28
    v_add_f32 v24, v24, v28
    s_mov_b32 s94, 0x3b000000
    v_mul_f32 v24, s94, v24
    v_sub_f32 v16, v16, v24
    v_sub_f32 v17, v17, v24
    v_sub_f32 v18, v18, v24
    v_sub_f32 v19, v19, v24
    v_sub_f32 v20, v20, v24
    v_sub_f32 v21, v21, v24
    v_sub_f32 v22, v22, v24
    v_sub_f32 v23, v23, v24
    v_mul_f32 v25, v16, v16
    v_fmac_f32 v25, v17, v17
    v_fmac_f32 v25, v18, v18
    v_fmac_f32 v25, v19, v19
    v_fmac_f32 v25, v20, v20
    v_fmac_f32 v25, v21, v21
    v_fmac_f32 v25, v22, v22
    v_fmac_f32 v25, v23, v23
    s_nop 1
    v_add_f32_dpp v25, v25, v25 quad_perm:[1,0,3,2] row_mask:0xf bank_mask:0xf
    s_nop 1
    v_add_f32_dpp v25, v25, v25 quad_perm:[2,3,0,1] row_mask:0xf bank_mask:0xf
    s_nop 1
    v_add_f32_dpp v25, v25, v25 row_half_mirror row_mask:0xf bank_mask:0xf
    s_nop 1
    v_add_f32_dpp v25, v25, v25 row_mirror row_mask:0xf bank_mask:0xf
    v_mov_b32 v28, v25
    s_nop 1
    v_permlane16_swap_b32 v25, v28
    v_add_f32 v25, v25, v28
    v_mov_b32 v28, v25
    s_nop 1
    v_permlane32_swap_b32 v25, v28
    v_add_f32 v25, v25, v28
    v_mul_f32 v25, s94, v25
    v_lshlrev_b32 v12, 16, v8
    v_and_b32 v13, 0xffff0000, v8
    v_cvt_pk_bf16_f32 v28, v24, v25
    v_lshlrev_b32 v24, 16, v28
    v_and_b32 v25, 0xffff0000, v28
    s_mov_b32 s94, 0x3727c5ac
    v_add_f32 v25, s94, v25
    v_cvt_pk_bf16_f32 v25, v25, v25
    v_lshlrev_b32 v25, 16, v25
    v_sqrt_f32 v25, v25
    v_sub_f32 v12, v12, v24
    v_sub_f32 v13, v13, v24
    v_cvt_pk_bf16_f32 v25, v25, v25
    v_lshlrev_b32 v25, 16, v25
    v_rcp_f32 v25, v25
    v_cvt_pk_bf16_f32 v28, v12, v13
    v_lshlrev_b32 v12, 16, v28
    v_and_b32 v13, 0xffff0000, v28
    v_mul_f32 v12, v12, v25
    v_mul_f32 v13, v13, v25
    v_cvt_pk_bf16_f32 v28, v12, v13
    v_lshlrev_b32 v12, 16, v28
    v_and_b32 v13, 0xffff0000, v28
    s_lshr_b32 s90, s7, 1
    s_and_b32 s91, s7, 1
    s_lshl_b32 s99, s4, 15
    s_lshl_b32 s94, s97, 14
    s_add_u32 s99, s99, s94
    s_lshl_b32 s94, s90, 12
    s_add_u32 s99, s99, s94
    s_lshl_b32 s94, s91, 9
    s_add_u32 s99, s99, s94
    s_add_u32 s99, s99, 262144
    s_mov_b32 exec_hi, 0
    buffer_load_dwordx4 v[16:19], v1, s[12:15], s99 offen offset:0 sc1
    buffer_load_dwordx4 v[20:23], v1, s[12:15], s99 offen offset:1024 sc1
    buffer_load_dwordx4 v[24:27], v1, s[12:15], s99 offen offset:2048 sc1
    buffer_load_dwordx4 v[28:31], v1, s[12:15], s99 offen offset:3072 sc1
    s_mov_b32 exec_hi, -1
    s_lshr_b32 s100, s7, 1
    s_lshl_b32 s90, s97, 14
    s_lshl_b32 s94, s100, 12
    s_add_u32 s90, s90, s94
    s_add_u32 s90, s90, 4096
    s_lshl_b32 s99, s97, 14
    s_lshl_b32 s94, s100, 12
    s_add_u32 s99, s99, s94
    s_add_u32 s99, s99, 36864
    s_sleep 4
    s_mov_b64 s[42:43], exec
Lpl_45:
    buffer_load_dwordx4 v[16:19], v1, s[12:15], s90 offen offset:0 sc1
    buffer_load_dwordx4 v[32:35], v1, s[12:15], s99 offen offset:0 sc1
    buffer_load_dwordx4 v[20:23], v1, s[12:15], s90 offen offset:1024 sc1
    buffer_load_dwordx4 v[36:39], v1, s[12:15], s99 offen offset:1024 sc1
    buffer_load_dwordx4 v[24:27], v1, s[12:15], s90 offen offset:2048 sc1
    buffer_load_dwordx4 v[40:43], v1, s[12:15], s99 offen offset:2048 sc1
    buffer_load_dwordx4 v[28:31], v1, s[12:15], s90 offen offset:3072 sc1
    buffer_load_dwordx4 v[44:47], v1, s[12:15], s99 offen offset:3072 sc1
    s_waitcnt vmcnt(0)
    v_xor_b32 v50, s10, v17
    v_bitop3_b32 v50, v50, v19, s10 bitop3:0xf6
    v_bitop3_b32 v50, v50, v33, s10 bitop3:0xf6
    v_bitop3_b32 v50, v50, v35, s10 bitop3:0xf6
    v_bitop3_b32 v50, v50, v21, s10 bitop3:0xf6
    v_bitop3_b32 v50, v50, v23, s10 bitop3:0xf6
    v_bitop3_b32 v50, v50, v37, s10 bitop3:0xf6
    v_bitop3_b32 v50, v50, v39, s10 bitop3:0xf6
    v_bitop3_b32 v50, v50, v25, s10 bitop3:0xf6
    v_bitop3_b32 v50, v50, v27, s10 bitop3:0xf6
    v_bitop3_b32 v50, v50, v41, s10 bitop3:0xf6
    v_bitop3_b32 v50, v50, v43, s10 bitop3:0xf6
    v_bitop3_b32 v50, v50, v29, s10 bitop3:0xf6
    v_bitop3_b32 v50, v50, v31, s10 bitop3:0xf6
    v_bitop3_b32 v50, v50, v45, s10 bitop3:0xf6
    v_bitop3_b32 v50, v50, v47, s10 bitop3:0xf6
    v_cmp_ne_u32 vcc, 0, v50
    s_cbranch_vccz Lple_46
    s_mov_b64 exec, vcc
    s_sub_u32 s11, s11, 1
    s_cbranch_scc1 L_abort
    s_sleep 1
    s_branch Lpl_45
Lple_46:
    s_mov_b64 exec, s[42:43]
    v_add_f32 v14, v16, v20
    v_add_f32 v15, v18, v22
    v_add_f32 v50, v24, v28
    v_add_f32 v51, v26, v30
    v_add_f32 v14, v14, v50
    v_add_f32 v15, v15, v51
    v_cvt_pk_bf16_f32 v50, v14, v15
    v_lshlrev_b32 v14, 16, v50
    v_and_b32 v15, 0xffff0000, v50
    v_add_f32 v48, v32, v36
    v_add_f32 v49, v34, v38
    v_add_f32 v50, v40, v44
    v_add_f32 v51, v42, v46
    v_add_f32 v48, v48, v50
    v_add_f32 v49, v49, v51
    v_cvt_pk_bf16_f32 v50, v48, v49
    v_lshlrev_b32 v48, 16, v50
    v_and_b32 v49, 0xffff0000, v50
    v_add_f32 v48, 1.0, v48
    v_add_f32 v49, 1.0, v49
    v_cvt_pk_bf16_f32 v50, v48, v49
    v_lshlrev_b32 v48, 16, v50
    v_and_b32 v49, 0xffff0000, v50
    v_mul_f32 v12, v12, v48
    v_mul_f32 v13, v13, v49
    v_cvt_pk_bf16_f32 v50, v12, v13
    v_lshlrev_b32 v12, 16, v50
    v_and_b32 v13, 0xffff0000, v50
    v_add_f32 v12, v12, v14
    v_add_f32 v13, v13, v15
    v_cvt_pk_bf16_f32 v16, v12, v13
    ds_write_b32 v11, v16 offset:1344
    s_mov_b64 s[92:93], exec
    s_mov_b64 exec, 1
    ds_add_u32 v3, v10 offset:8
    s_mov_b64 exec, s[92:93]
    s_lshr_b32 s90, s7, 1
    s_and_b32 s91, s7, 1
    s_lshl_b32 s99, s4, 15
    s_lshl_b32 s94, s97, 14
    s_add_u32 s99, s99, s94
    s_lshl_b32 s94, s90, 12
    s_add_u32 s99, s99, s94
    s_lshl_b32 s94, s91, 9
    s_add_u32 s99, s99, s94
    s_add_u32 s99, s99, 262144
    s_lshl_b32 s100, s4, 12
    s_lshl_b32 s94, s97, 11
    s_add_u32 s100, s100, s94
    s_lshl_b32 s94, s7, 8
    s_add_u32 s100, s100, s94
    s_add_u32 s100, s100, 557056
    v_lshlrev_b32 v54, 3, v0
    s_mov_b32 exec_hi, 0
Lsp_48:
    ds_read_b32 v50, v3 offset:80
    s_waitcnt lgkmcnt(0)
    v_readfirstlane_b32 s91, v50
    s_nop 0
    s_cmp_ge_i32 s91, 1
    s_cbranch_scc1 Lspe_49
    s_sub_u32 s11, s11, 1
    s_cbranch_scc1 L_abort
    s_sleep 1
    s_branch Lsp_48
Lspe_49:
    s_mov_b32 s88, s91
Lsp_50:
    ds_read_b32 v50, v3 offset:60
    s_waitcnt lgkmcnt(0)
    v_readfirstlane_b32 s91, v50
    s_nop 0
    s_cmp_ge_i32 s91, 4
    s_cbranch_scc1 Lspe_51
    s_sub_u32 s11, s11, 1
    s_cbranch_scc1 L_abort
    s_branch Lsp_50
Lspe_51:
    s_sleep 1
    s_mov_b64 s[42:43], exec
Lpl_52:
    buffer_load_dwordx4 v[16:19], v1, s[12:15], s99 offen offset:0 sc1
    buffer_load_dwordx4 v[20:23], v1, s[12:15], s99 offen offset:1024 sc1
    buffer_load_dwordx4 v[24:27], v1, s[12:15], s99 offen offset:2048 sc1
    buffer_load_dwordx4 v[28:31], v1, s[12:15], s99 offen offset:3072 sc1
    s_waitcnt vmcnt(0)
    v_xor_b32 v50, s10, v17
    v_bitop3_b32 v50, v50, v19, s10 bitop3:0xf6
    v_bitop3_b32 v50, v50, v21, s10 bitop3:0xf6
    v_bitop3_b32 v50, v50, v23, s10 bitop3:0xf6
    v_bitop3_b32 v50, v50, v25, s10 bitop3:0xf6
    v_bitop3_b32 v50, v50, v27, s10 bitop3:0xf6
    v_bitop3_b32 v50, v50, v29, s10 bitop3:0xf6
    v_bitop3_b32 v50, v50, v31, s10 bitop3:0xf6
    v_cmp_ne_u32 vcc, 0, v50
    s_cbranch_vccz Lple_53
    s_mov_b64 exec, vcc
    s_sub_u32 s11, s11, 1
    s_cbranch_scc1 L_abort
    s_branch Lpl_52
Lple_53:
    s_mov_b64 exec, s[42:43]
    v_add_f32 v48, v16, v20
    v_add_f32 v49, v18, v22
    v_add_f32 v50, v24, v28
    v_add_f32 v51, v26, v30
    v_add_f32 v48, v48, v50
    v_add_f32 v49, v49, v51
    v_mov_b32 v53, s10
    v_cvt_pk_bf16_f32 v52, v48, v49
    s_cmp_eq_u32 s88, 1
    s_cbranch_scc1 Lst_55
    buffer_store_dwordx2 v[52:53], v54, s[12:15], s100 offen sc1
    s_branch Lste_56
Lst_55:
    buffer_store_dwordx2 v[52:53], v54, s[12:15], s100 offen
Lste_56:
    s_mov_b64 exec, -1
    s_mov_b64 s[92:93], exec
    s_mov_b64 exec, 1
    ds_add_u32 v3, v10 offset:64
    s_mov_b64 exec, s[92:93]
L_q_qg:
    s_lshl_b32 s90, s4, 12
    s_lshl_b32 s94, s86, 11
    s_add_u32 s90, s90, s94
    s_lshl_b32 s94, s97, 10
    s_add_u32 s90, s90, s94
    s_add_u32 s90, s90, 557056
    v_lshrrev_b32 v54, 5, v0
    v_mul_u32_u24 v54, 272, v54
    v_and_b32 v55, 31, v0
    v_lshl_add_u32 v54, v55, 3, v54
    s_mul_i32 s100, s97, 544
    v_add_u32 v54, s100, v54
    s_cmp_eq_u32 s6, 0
    s_cbranch_scc1 L_q_qA
Lsp_57:
    ds_read_b32 v50, v3 offset:64
    s_waitcnt lgkmcnt(0)
    v_readfirstlane_b32 s91, v50
    s_nop 0
    s_cmp_ge_i32 s91, 2
    s_cbranch_scc1 Lspe_58
    s_sub_u32 s11, s11, 1
    s_cbranch_scc1 L_abort
    s_branch Lsp_57
Lspe_58:
    s_sleep 1
    s_branch L_q_qP
L_q_qA:
Lsp_59:
    ds_read_b32 v50, v3 offset:0
    s_waitcnt lgkmcnt(0)
    v_readfirstlane_b32 s91, v50
    s_nop 0
    s_cmp_ge_i32 s91, 40
    s_cbranch_scc1 Lspe_60
    s_sub_u32 s11, s11, 1
    s_cbranch_scc1 L_abort
    s_sleep 1
    s_branch Lsp_59
Lspe_60:
L_q_qP:
    buffer_load_dwordx4 v[16:19], v1, s[12:15], s90 offen sc1
    s_sleep 6
L_q_loop:
    buffer_load_dwordx4 v[20:23], v1, s[12:15], s90 offen sc1
    s_waitcnt vmcnt(1)
    v_xor_b32 v50, s10, v17
    v_bitop3_b32 v50, v50, v19, s10 bitop3:0xf6
    v_cmp_ne_u32 vcc, 0, v50
    s_cbranch_vccz L_q_gotA
    s_sub_u32 s11, s11, 1
    s_cbranch_scc1 L_abort
    buffer_load_dwordx4 v[16:19], v1, s[12:15], s90 offen sc1
    s_waitcnt vmcnt(1)
    v_xor_b32 v50, s10, v21
    v_bitop3_b32 v50, v50, v23, s10 bitop3:0xf6
    v_cmp_ne_u32 vcc, 0, v50
    s_cbranch_vccnz L_q_loop
    v_mov_b32 v24, v20
    v_mov_b32 v25, v22
    s_branch L_q_got
L_q_gotA:
    v_mov_b32 v24, v16
    v_mov_b32 v25, v18
L_q_got:
    ds_write_b64 v54, v[24:25] offset:3648
    s_mov_b64 s[92:93], exec
    s_mov_b64 exec, 1
    ds_add_u32 v3, v10 offset:12
    s_mov_b64 exec, s[92:93]
    s_waitcnt vmcnt(0)
    s_mul_i32 s99, s6, -45
    s_add_u32 s99, s99, 100
Lsp_61:
    ds_read_b32 v50, v3 offset:0
    s_waitcnt lgkmcnt(0)
    v_readfirstlane_b32 s91, v50
    s_nop 0
    s_cmp_ge_i32 s91, s99
    s_cbranch_scc1 Lspe_62
    s_sub_u32 s11, s11, 1
    s_cbranch_scc1 L_abort
    s_sleep 1
    s_branch Lsp_61
Lspe_62:
    s_lshl_b32 s90, s97, 11
    s_lshl_b32 s94, s8, 9
    s_add_u32 s90, s90, s94
    s_add_u32 s90, s90, 241664
    s_add_u32 s99, s90, 4096
    v_lshlrev_b32 v54, 3, v0
    s_mul_i32 s94, s8, 448
    s_lshl_b32 s24, s4, 15
    s_lshl_b32 s25, s97, 13
    s_add_u32 s24, s24, s25
    s_mov_b32 s25, s94
    s_add_u32 s24, s24, s25
    s_add_u32 s24, s24, 1441792
    s_add_u32 s25, s24, 4096
    s_add_u32 s26, s24, 16384
    s_add_u32 s27, s24, 20480
    buffer_load_dwordx2 v[20:21], v54, s[12:15], s24 offen offset:0 sc1
    buffer_load_dwordx2 v[22:23], v54, s[12:15], s24 offen offset:2048 sc1
    buffer_load_dwordx2 v[24:25], v54, s[12:15], s25 offen offset:0 sc1
    buffer_load_dwordx2 v[26:27], v54, s[12:15], s25 offen offset:2048 sc1
    buffer_load_dwordx2 v[28:29], v54, s[12:15], s26 offen offset:0 sc1
    buffer_load_dwordx2 v[30:31], v54, s[12:15], s26 offen offset:2048 sc1
    buffer_load_dwordx2 v[32:33], v54, s[12:15], s27 offen offset:0 sc1
    buffer_load_dwordx2 v[34:35], v54, s[12:15], s27 offen offset:2048 sc1
    s_lshl_b32 s24, s4, 10
    s_lshl_b32 s94, s97, 9
    s_add_u32 s24, s24, s94
    s_add_u32 s24, s24, 1409024
    s_lshl_b32 s25, s4, 12
    s_lshl_b32 s94, s97, 11
    s_add_u32 s25, s25, s94
    s_lshl_b32 s94, s8, 9
    s_add_u32 s25, s25, s94
    s_add_u32 s25, s25, 1376256
    buffer_load_dwordx2 v[36:37], v54, s[12:15], s24 offen sc1
    buffer_load_dwordx2 v[38:39], v54, s[12:15], s25 offen sc1
    s_mov_b64 s[42:43], exec
Lpl_63:
    buffer_load_dwordx2 v[16:17], v54, s[12:15], s90 offen sc1
    buffer_load_dwordx2 v[18:19], v54, s[12:15], s99 offen sc1
    s_waitcnt vmcnt(0)
    v_xor_b32 v50, s10, v17
    v_bitop3_b32 v50, v50, v19, s10 bitop3:0xf6
    v_cmp_ne_u32 vcc, 0, v50
    s_cbranch_vccz Lple_64
    s_mov_b64 exec, vcc
    s_sub_u32 s11, s11, 1
    s_cbranch_scc1 L_abort
    s_sleep 8
    s_branch Lpl_63
Lple_64:
    s_mov_b64 exec, s[42:43]
    v_lshlrev_b32 v66, 16, v16
    v_and_b32 v67, 0xffff0000, v16
    v_lshlrev_b32 v48, 16, v18
    v_and_b32 v49, 0xffff0000, v18
    v_add_f32 v48, 1.0, v48
    v_add_f32 v49, 1.0, v49
    v_cvt_pk_bf16_f32 v50, v48, v49
    v_lshlrev_b32 v64, 16, v50
    v_and_b32 v65, 0xffff0000, v50
    s_sub_u32 s90, s3, 4
    s_lshr_b32 s91, s90, 1
    s_and_b32 s94, s90, 1
    s_lshl_b32 s99, s94, 8
    s_lshl_b32 s100, s4, 16
    s_add_u32 s99, s99, s100
    s_lshl_b32 s100, s8, 14
    s_add_u32 s99, s99, s100
    s_lshl_b32 s100, s91, 13
    s_add_u32 s99, s99, s100
    s_add_u32 s99, s99, 589824
    s_lshl_b32 s100, s4, 11
    s_lshl_b32 s90, s91, 10
    s_add_u32 s100, s100, s90
    s_lshl_b32 s90, s8, 8
    s_add_u32 s100, s100, s90
    s_add_u32 s100, s100, 524288
    v_lshrrev_b32 v48, 5, v0
    v_and_b32 v49, 31, v0
    v_lshlrev_b32 v50, 12, v48
    v_lshl_add_u32 v50, v49, 3, v50
    v_and_b32 v51, 7, v0
    v_lshl_add_u32 v51, v48, 3, v51
    v_lshlrev_b32 v51, 4, v51
    s_mul_i32 s91, s91, 272
    s_lshl_b32 s94, s94, 7
    s_add_u32 s91, s91, s94
    v_bfe_u32 v52, v0, 4, 1
    v_lshlrev_b32 v52, 6, v52
    v_and_b32 v53, 15, v0
    v_lshl_add_u32 v52, v53, 1, v52
    v_lshl_add_u32 v52, v48, 5, v52
    v_add_u32 v52, s91, v52
    buffer_load_dwordx4 v[32:35], v51, s[12:15], s100 offen sc1
    buffer_load_dwordx2 v[16:17], v50, s[12:15], s99 offen offset:0 sc1
    buffer_load_dwordx2 v[18:19], v50, s[12:15], s99 offen offset:512 sc1
    buffer_load_dwordx2 v[20:21], v50, s[12:15], s99 offen offset:1024 sc1
    buffer_load_dwordx2 v[22:23], v50, s[12:15], s99 offen offset:1536 sc1
    buffer_load_dwordx2 v[24:25], v50, s[12:15], s99 offen offset:2048 sc1
    buffer_load_dwordx2 v[26:27], v50, s[12:15], s99 offen offset:2560 sc1
    buffer_load_dwordx2 v[28:29], v50, s[12:15], s99 offen offset:3072 sc1
    buffer_load_dwordx2 v[30:31], v50, s[12:15], s99 offen offset:3584 sc1
Lsp_66:
    ds_read_b32 v54, v3 offset:36
    s_waitcnt lgkmcnt(0)
    v_readfirstlane_b32 s91, v54
    s_nop 0
    s_cmp_ge_i32 s91, 4
    s_cbranch_scc1 Lspe_67
    s_sub_u32 s11, s11, 1
    s_cbranch_scc1 L_abort
    s_branch Lsp_66
Lspe_67:
    s_sleep 1
    s_mov_b64 s[42:43], exec
Lpl_68:
    buffer_load_dwordx4 v[32:35], v51, s[12:15], s100 offen sc1
    buffer_load_dwordx2 v[16:17], v50, s[12:15], s99 offen offset:0 sc1
    buffer_load_dwordx2 v[18:19], v50, s[12:15], s99 offen offset:512 sc1
    buffer_load_dwordx2 v[20:21], v50, s[12:15], s99 offen offset:1024 sc1
    buffer_load_dwordx2 v[22:23], v50, s[12:15], s99 offen offset:1536 sc1
    buffer_load_dwordx2 v[24:25], v50, s[12:15], s99 offen offset:2048 sc1
    buffer_load_dwordx2 v[26:27], v50, s[12:15], s99 offen offset:2560 sc1
    buffer_load_dwordx2 v[28:29], v50, s[12:15], s99 offen offset:3072 sc1
    buffer_load_dwordx2 v[30:31], v50, s[12:15], s99 offen offset:3584 sc1
    s_waitcnt vmcnt(0)
    v_xor_b32 v54, s10, v33
    v_bitop3_b32 v54, v54, v35, s10 bitop3:0xf6
    v_bitop3_b32 v54, v54, v17, s10 bitop3:0xf6
    v_bitop3_b32 v54, v54, v19, s10 bitop3:0xf6
    v_bitop3_b32 v54, v54, v21, s10 bitop3:0xf6
    v_bitop3_b32 v54, v54, v23, s10 bitop3:0xf6
    v_bitop3_b32 v54, v54, v25, s10 bitop3:0xf6
    v_bitop3_b32 v54, v54, v27, s10 bitop3:0xf6
    v_bitop3_b32 v54, v54, v29, s10 bitop3:0xf6
    v_bitop3_b32 v54, v54, v31, s10 bitop3:0xf6
    v_cmp_ne_u32 vcc, 0, v54
    s_cbranch_vccz Lple_69
    s_mov_b64 exec, vcc
    s_sub_u32 s11, s11, 1
    s_cbranch_scc1 L_abort
    s_branch Lpl_68
Lple_69:
    s_mov_b64 exec, s[42:43]
    v_mov_b32 v55, v32
    s_nop 1
    v_max_f32_dpp v55, v55, v55 quad_perm:[1,0,3,2] row_mask:0xf bank_mask:0xf
    s_nop 1
    v_max_f32_dpp v55, v55, v55 quad_perm:[2,3,0,1] row_mask:0xf bank_mask:0xf
    s_nop 1
    v_max_f32_dpp v55, v55, v55 row_half_mirror row_mask:0xf bank_mask:0xf
    v_mov_b32 v56, v55
    s_nop 1
    v_permlane32_swap_b32 v55, v56
    v_max_f32 v55, v55, v56
    s_mov_b32 s94, 0x3fb8aa3b
    v_sub_f32 v56, v32, v55
    v_lshlrev_b32 v36, 16, v16
    v_and_b32 v37, 0xffff0000, v16
    v_lshlrev_b32 v38, 16, v18
    v_and_b32 v39, 0xffff0000, v18
    v_lshlrev_b32 v40, 16, v20
    v_and_b32 v41, 0xffff0000, v20
    v_lshlrev_b32 v42, 16, v22
    v_and_b32 v43, 0xffff0000, v22
    v_mul_f32 v56, s94, v56
    v_exp_f32 v56, v56
    v_lshlrev_b32 v44, 16, v24
    v_and_b32 v45, 0xffff0000, v24
    v_lshlrev_b32 v46, 16, v26
    v_and_b32 v47, 0xffff0000, v26
    v_lshlrev_b32 v48, 16, v28
    v_and_b32 v49, 0xffff0000, v28
    v_lshlrev_b32 v50, 16, v30
    v_and_b32 v51, 0xffff0000, v30
    v_mul_f32 v57, v56, v34
    s_nop 1
    v_add_f32_dpp v57, v57, v57 quad_perm:[1,0,3,2] row_mask:0xf bank_mask:0xf
    s_nop 1
    v_add_f32_dpp v57, v57, v57 quad_perm:[2,3,0,1] row_mask:0xf bank_mask:0xf
    s_nop 1
    v_add_f32_dpp v57, v57, v57 row_half_mirror row_mask:0xf bank_mask:0xf
    v_mov_b32 v58, v57
    s_nop 1
    v_permlane32_swap_b32 v57, v58
    v_add_f32 v57, v57, v58
    v_rcp_f32 v57, v57
    v_mov_b32 v58, 0
    v_mov_b32 v59, 0
    v_mul_f32 v56, v56, v57
    s_nop 1
    v_fmac_f32_dpp v58, v56, v36 row_newbcast:0 row_mask:0xf bank_mask:0xf
    v_fmac_f32_dpp v59, v56, v37 row_newbcast:0 row_mask:0xf bank_mask:0xf
    s_nop 0
    v_fmac_f32_dpp v58, v56, v38 row_newbcast:1 row_mask:0xf bank_mask:0xf
    v_fmac_f32_dpp v59, v56, v39 row_newbcast:1 row_mask:0xf bank_mask:0xf
    s_nop 0
    v_fmac_f32_dpp v58, v56, v40 row_newbcast:2 row_mask:0xf bank_mask:0xf
    v_fmac_f32_dpp v59, v56, v41 row_newbcast:2 row_mask:0xf bank_mask:0xf
    s_nop 0
    v_fmac_f32_dpp v58, v56, v42 row_newbcast:3 row_mask:0xf bank_mask:0xf
    v_fmac_f32_dpp v59, v56, v43 row_newbcast:3 row_mask:0xf bank_mask:0xf
    s_nop 0
    v_fmac_f32_dpp v58, v56, v44 row_newbcast:4 row_mask:0xf bank_mask:0xf
    v_fmac_f32_dpp v59, v56, v45 row_newbcast:4 row_mask:0xf bank_mask:0xf
    s_nop 0
    v_fmac_f32_dpp v58, v56, v46 row_newbcast:5 row_mask:0xf bank_mask:0xf
    v_fmac_f32_dpp v59, v56, v47 row_newbcast:5 row_mask:0xf bank_mask:0xf
    s_nop 0
    v_fmac_f32_dpp v58, v56, v48 row_newbcast:6 row_mask:0xf bank_mask:0xf
    v_fmac_f32_dpp v59, v56, v49 row_newbcast:6 row_mask:0xf bank_mask:0xf
    s_nop 0
    v_fmac_f32_dpp v58, v56, v50 row_newbcast:7 row_mask:0xf bank_mask:0xf
    v_fmac_f32_dpp v59, v56, v51 row_newbcast:7 row_mask:0xf bank_mask:0xf
    s_nop 1
    v_permlane32_swap_b32 v58, v59
    v_add_f32 v58, v58, v59
    v_cvt_pk_bf16_f32 v58, v58, v58
    ds_write_b16 v52, v58 offset:1920
    s_waitcnt lgkmcnt(0)
    s_barrier
    s_lshl_b32 s99, s4, 10
    s_lshl_b32 s94, s97, 9
    s_add_u32 s99, s99, s94
    s_add_u32 s99, s99, 1409024
    s_lshl_b32 s90, s4, 12
    s_lshl_b32 s94, s97, 11
    s_add_u32 s90, s90, s94
    s_lshl_b32 s94, s8, 9
    s_add_u32 s90, s90, s94
    s_add_u32 s90, s90, 1376256
    v_lshlrev_b32 v16, 3, v0
    v_and_b32 v17, 31, v0
    v_lshlrev_b32 v17, 4, v17
Lsp_71:
    ds_read_b32 v50, v3 offset:44
    s_waitcnt lgkmcnt(0)
    v_readfirstlane_b32 s91, v50
    s_nop 0
    s_cmp_ge_i32 s91, 1
    s_cbranch_scc1 Lspe_72
    s_sub_u32 s11, s11, 1
    s_cbranch_scc1 L_abort
    s_branch Lsp_71
Lspe_72:
    s_sleep 1
    s_mov_b64 s[42:43], exec
Lpl_73:
    buffer_load_dwordx4 v[24:27], v17, s[12:15], s99 offen sc1
    buffer_load_dwordx2 v[20:21], v16, s[12:15], s90 offen sc1
    s_waitcnt vmcnt(0)
    v_xor_b32 v50, s10, v21
    v_bitop3_b32 v50, v50, v25, s10 bitop3:0xf6
    v_bitop3_b32 v50, v50, v27, s10 bitop3:0xf6
    v_cmp_ne_u32 vcc, 0, v50
    s_cbranch_vccz Lple_74
    s_mov_b64 exec, vcc
    s_sub_u32 s11, s11, 1
    s_cbranch_scc1 L_abort
    s_branch Lpl_73
Lple_74:
    s_mov_b64 exec, s[42:43]
    v_add_f32_dpp v24, v24, v24 quad_perm:[1,0,3,2] row_mask:0xf bank_mask:0xf
    v_add_f32_dpp v26, v26, v26 quad_perm:[1,0,3,2] row_mask:0xf bank_mask:0xf
    s_nop 0
    v_add_f32_dpp v24, v24, v24 quad_perm:[2,3,0,1] row_mask:0xf bank_mask:0xf
    v_add_f32_dpp v26, v26, v26 quad_perm:[2,3,0,1] row_mask:0xf bank_mask:0xf
    s_nop 0
    v_add_f32_dpp v24, v24, v24 row_half_mirror row_mask:0xf bank_mask:0xf
    v_add_f32_dpp v26, v26, v26 row_half_mirror row_mask:0xf bank_mask:0xf
    s_nop 0
    v_add_f32_dpp v24, v24, v24 row_mirror row_mask:0xf bank_mask:0xf
    v_add_f32_dpp v26, v26, v26 row_mirror row_mask:0xf bank_mask:0xf
    v_mov_b32 v28, v24
    v_mov_b32 v29, v26
    s_nop 0
    v_permlane16_swap_b32 v24, v28
    v_permlane16_swap_b32 v26, v29
    v_add_f32 v24, v24, v28
    v_add_f32 v26, v26, v29
    s_mov_b32 s94, 0x3b000000
    v_mul_f32 v24, s94, v24
    v_mul_f32 v26, s94, v26
    v_lshlrev_b32 v12, 16, v20
    v_fma_f32 v26, -v24, v24, v26
    v_and_b32 v13, 0xffff0000, v20
    v_max_f32 v26, 0, v26
    v_cvt_pk_bf16_f32 v30, v24, v26
    v_lshlrev_b32 v24, 16, v30
    v_and_b32 v26, 0xffff0000, v30
    s_mov_b32 s94, 0x3727c5ac
    v_add_f32 v26, s94, v26
    v_cvt_pk_bf16_f32 v26, v26, v26
    v_lshlrev_b32 v26, 16, v26
    v_sqrt_f32 v26, v26
    v_sub_f32 v12, v12, v24
    v_sub_f32 v13, v13, v24
    v_cvt_pk_bf16_f32 v26, v26, v26
    v_lshlrev_b32 v26, 16, v26
    v_rcp_f32 v26, v26
    v_cvt_pk_bf16_f32 v30, v12, v13
    v_lshlrev_b32 v12, 16, v30
    v_and_b32 v13, 0xffff0000, v30
    v_mul_f32 v12, v12, v26
    v_mul_f32 v13, v13, v26
    v_cvt_pk_bf16_f32 v30, v12, v13
    v_lshlrev_b32 v12, 16, v30
    v_and_b32 v13, 0xffff0000, v30
    v_mul_f32 v12, v12, v64
    v_mul_f32 v13, v13, v65
    v_cvt_pk_bf16_f32 v30, v12, v13
    v_lshlrev_b32 v12, 16, v30
    v_and_b32 v13, 0xffff0000, v30
    v_add_f32 v12, v12, v66
    v_add_f32 v13, v13, v67
    v_cvt_pk_bf16_f32 v16, v12, v13
    ds_write_b32 v11, v16 offset:2496
    s_mul_i32 s94, s8, 448
    s_lshl_b32 s90, s4, 15
    s_lshl_b32 s99, s97, 13
    s_add_u32 s90, s90, s99
    s_mov_b32 s99, s94
    s_add_u32 s90, s90, s99
    s_add_u32 s90, s90, 1441792
    s_add_u32 s94, s90, 4096
    s_add_u32 s99, s90, 16384
    s_add_u32 s100, s90, 20480
    s_waitcnt lgkmcnt(0)
    s_barrier
    v_lshlrev_b32 v16, 3, v0
    v_mov_b32 v40, 0
    v_lshlrev_b32 v17, 1, v0
    v_add_u32 v17, s98, v17
    s_mov_b32 exec_lo, -1
    s_mov_b32 exec_hi, 0x00ffffff
Lsp_76:
    ds_read_b32 v50, v3 offset:48
    s_waitcnt lgkmcnt(0)
    v_readfirstlane_b32 s91, v50
    s_nop 0
    s_cmp_ge_i32 s91, 4
    s_cbranch_scc1 Lspe_77
    s_sub_u32 s11, s11, 1
    s_cbranch_scc1 L_abort
    s_branch Lsp_76
Lspe_77:
    s_sleep 1
    s_mov_b64 s[42:43], exec
Lpl_78:
    buffer_load_dwordx2 v[20:21], v16, s[12:15], s90 offen offset:0 sc1
    buffer_load_dwordx2 v[22:23], v16, s[12:15], s90 offen offset:2048 sc1
    buffer_load_dwordx2 v[24:25], v16, s[12:15], s94 offen offset:0 sc1
    buffer_load_dwordx2 v[26:27], v16, s[12:15], s94 offen offset:2048 sc1
    buffer_load_dwordx2 v[28:29], v16, s[12:15], s99 offen offset:0 sc1
    buffer_load_dwordx2 v[30:31], v16, s[12:15], s99 offen offset:2048 sc1
    buffer_load_dwordx2 v[32:33], v16, s[12:15], s100 offen offset:0 sc1
    buffer_load_dwordx2 v[34:35], v16, s[12:15], s100 offen offset:2048 sc1
    s_waitcnt vmcnt(0)
    v_xor_b32 v50, s10, v21
    v_bitop3_b32 v50, v50, v23, s10 bitop3:0xf6
    v_bitop3_b32 v50, v50, v25, s10 bitop3:0xf6
    v_bitop3_b32 v50, v50, v27, s10 bitop3:0xf6
    v_bitop3_b32 v50, v50, v29, s10 bitop3:0xf6
    v_bitop3_b32 v50, v50, v31, s10 bitop3:0xf6
    v_bitop3_b32 v50, v50, v33, s10 bitop3:0xf6
    v_bitop3_b32 v50, v50, v35, s10 bitop3:0xf6
    v_cmp_ne_u32 vcc, 0, v50
    s_cbranch_vccz Lple_79
    s_mov_b64 exec, vcc
    s_sub_u32 s11, s11, 1
    s_cbranch_scc1 L_abort
    s_branch Lpl_78
Lple_79:
    s_mov_b64 exec, s[42:43]
    v_add_f32 v36, v20, v22
    v_add_f32 v37, v24, v26
    v_add_f32 v38, v28, v30
    v_add_f32 v39, v32, v34
    v_add_f32 v36, v36, v37
    v_add_f32 v38, v38, v39
    v_cvt_pk_bf16_f32 v50, v36, v38
    v_lshlrev_b32 v36, 16, v50
    v_and_b32 v38, 0xffff0000, v50
    v_mul_f32 v36, v36, v38
    v_cvt_pk_bf16_f32 v40, v36, v36
    s_mov_b64 exec, -1
    ds_write_b16 v17, v40 offset:3072
    s_waitcnt lgkmcnt(0)
    s_barrier
    s_endpgm
L_slice:
    s_mov_b32 s48, s38
    s_and_b32 s49, s39, 0xffff
    s_mov_b32 s50, 2048
    s_mov_b32 s51, 0x20000
    v_lshlrev_b32 v7, 4, v0
    v_and_b32 v1, 3, v0
    v_bfe_u32 v2, v0, 4, 1
    v_bfe_u32 v4, v0, 3, 1
    v_lshrrev_b32 v5, 5, v0
    v_lshlrev_b32 v6, 2, v1
    v_lshl_add_u32 v6, v2, 1, v6
    v_add_u32 v6, v6, v4
    v_lshlrev_b32 v8, 10, v5
    v_lshl_add_u32 v8, v6, 1, v8
    s_lshl_b32 s90, s5, 5
    buffer_load_ushort v9, v8, s[44:47], s90 offen
    v_lshlrev_b32 v10, 4, v5
    v_add_u32 v10, v10, v6
    v_lshlrev_b32 v10, 2, v10
    v_lshlrev_b32 v11, 1, v1
    v_add_u32 v11, v11, v2
    v_lshlrev_b32 v12, 11, v5
    v_lshl_add_u32 v98, v11, 3, v12
    v_lshlrev_b32 v99, 9, v5
    v_lshlrev_b32 v12, 10, v5
    v_lshl_add_u32 v97, v11, 2, v12
    s_lshl_b32 s22, s4, 12
    s_lshl_b32 s94, s5, 6
    s_add_u32 s22, s22, s94
    s_add_u32 s22, s22, 1376256
    s_lshl_b32 s23, s4, 10
    s_lshl_b32 s94, s5, 4
    s_add_u32 s23, s23, s94
    s_add_u32 s23, s23, 1409024
    s_lshl_b32 s24, s5, 5
    s_lshl_b32 s17, s5, 12
    v_cmp_eq_u32 s[26:27], 1, v4
    v_mov_b32 v100, 0x3f80
    v_mov_b32 v101, 0x3f800000
    s_waitcnt vmcnt(0)
    v_readfirstlane_b32 s89, v3
    s_nop 0
    s_add_u32 s89, s89, 1
    s_mul_i32 s10, s89, 0x9E3779B1
    v_mov_b32 v3, 0
    v_lshlrev_b32 v102, 16, v9
Lsp_81:
    ds_read_b32 v20, v3 offset:80
    s_waitcnt lgkmcnt(0)
    v_readfirstlane_b32 s91, v20
    s_nop 0
    s_cmp_ge_i32 s91, 1
    s_cbranch_scc1 Lspe_82
    s_sub_u32 s11, s11, 1
    s_cbranch_scc1 L_abort
    s_sleep 1
    s_branch Lsp_81
Lspe_82:
    s_mov_b32 s88, s91
    s_add_u32 s20, s17, 1114112
Lsp_83:
    ds_read_b32 v15, v3 offset:28
    s_waitcnt lgkmcnt(0)
    v_readfirstlane_b32 s91, v15
    s_nop 0
    s_cmp_ge_i32 s91, 4
    s_cbranch_scc1 Lspe_84
    s_sub_u32 s11, s11, 1
    s_cbranch_scc1 L_abort
    s_sleep 1
    s_branch Lsp_83
Lspe_84:
    v_lshrrev_b32 v16, 4, v0
    v_and_b32 v17, 15, v0
    v_mul_u32_u24 v18, 592, v16
    v_lshl_add_u32 v18, v17, 2, v18
    v_lshlrev_b32 v19, 2, v16
    v_mov_b32 v20, 0
    v_mov_b32 v21, 0x3f803f80
    ds_read_b32 v24, v19 offset:128
    ds_read_b32 v25, v19 offset:144
    ds_read_b32 v26, v19 offset:160
    ds_read_b32 v27, v19 offset:176
    ds_read_b32 v32, v18 offset:4736
    ds_read_b32 v33, v18 offset:4800
    ds_read_b32 v34, v18 offset:4864
    ds_read_b32 v35, v18 offset:4928
    ds_read_b32 v36, v18 offset:4992
    s_cmp_lg_u32 s6, 0
    s_cbranch_scc1 L_sl_stB
    ds_read_b32 v37, v18 offset:5056
    ds_read_b32 v38, v18 offset:5120
    ds_read_b32 v39, v18 offset:5184
    ds_read_b32 v40, v18 offset:5248
    s_waitcnt lgkmcnt(0)
    v_dot2_f32_bf16 v20, v37, v21, v20
    v_dot2_f32_bf16 v20, v38, v21, v20
    v_dot2_f32_bf16 v20, v39, v21, v20
    v_dot2_f32_bf16 v20, v40, v21, v20
L_sl_stB:
    s_waitcnt lgkmcnt(0)
    v_dot2_f32_bf16 v20, v32, v21, v20
    v_dot2_f32_bf16 v20, v33, v21, v20
    v_dot2_f32_bf16 v20, v34, v21, v20
    v_dot2_f32_bf16 v20, v35, v21, v20
    v_dot2_f32_bf16 v20, v36, v21, v20
    s_nop 2
    v_add_f32_dpp v20, v20, v20 quad_perm:[1,0,3,2] row_mask:0xf bank_mask:0xf
    s_nop 1
    v_add_f32_dpp v20, v20, v20 quad_perm:[2,3,0,1] row_mask:0xf bank_mask:0xf
    s_nop 1
    v_add_f32_dpp v20, v20, v20 row_half_mirror row_mask:0xf bank_mask:0xf
    s_nop 1
    v_add_f32_dpp v20, v20, v20 row_mirror row_mask:0xf bank_mask:0xf
    v_max3_f32 v24, v24, v25, v26
    v_max_f32 v24, v24, v27
    v_mov_b32 v25, s10
    v_mov_b32 v26, v20
    v_mov_b32 v27, s10
    v_lshlrev_b32 v22, 8, v16
    s_lshl_b32 s25, s4, 11
    s_lshl_b32 s94, s86, 10
    s_add_u32 s25, s25, s94
    s_lshl_b32 s94, s87, 4
    s_add_u32 s25, s25, s94
    s_add_u32 s25, s25, 524288
    s_mov_b32 exec_lo, 0x00010001
    s_mov_b32 exec_hi, 0x00010001
    s_cmp_eq_u32 s88, 1
    s_cbranch_scc1 Lst_85
    buffer_store_dwordx4 v[24:27], v22, s[12:15], s25 offen sc1
    s_branch Lste_86
Lst_85:
    buffer_store_dwordx4 v[24:27], v22, s[12:15], s25 offen
Lste_86:
    s_mov_b64 exec, -1
Lsp_87:
    ds_read_b32 v15, v3 offset:84
    s_waitcnt lgkmcnt(0)
    v_readfirstlane_b32 s91, v15
    s_nop 0
    s_cmp_ge_i32 s91, 1
    s_cbranch_scc1 Lspe_88
    s_sub_u32 s11, s11, 1
    s_cbranch_scc1 L_abort
    s_sleep 1
    s_branch Lsp_87
Lspe_88:
    ds_read_b32 v103, v10 offset:7168
    ds_read_b32 v104, v10 offset:7296
    s_waitcnt lgkmcnt(0)
    s_sub_u32 s90, s3, 4
    s_lshr_b32 s91, s90, 1
    s_and_b32 s94, s90, 1
    s_lshl_b32 s99, s94, 8
    s_lshl_b32 s100, s4, 16
    s_add_u32 s99, s99, s100
    s_lshl_b32 s100, s8, 14
    s_add_u32 s99, s99, s100
    s_lshl_b32 s100, s91, 13
    s_add_u32 s99, s99, s100
    s_add_u32 s99, s99, 589824
    s_lshl_b32 s100, s4, 11
    s_lshl_b32 s90, s91, 10
    s_add_u32 s100, s100, s90
    s_lshl_b32 s90, s8, 8
    s_add_u32 s100, s100, s90
    s_add_u32 s100, s100, 524288
    v_lshrrev_b32 v48, 5, v0
    v_and_b32 v49, 31, v0
    v_lshlrev_b32 v50, 12, v48
    v_lshl_add_u32 v50, v49, 3, v50
    v_and_b32 v51, 7, v0
    v_lshl_add_u32 v51, v48, 3, v51
    v_lshlrev_b32 v51, 4, v51
    s_mul_i32 s91, s91, 272
    s_lshl_b32 s94, s94, 7
    s_add_u32 s91, s91, s94
    v_bfe_u32 v52, v0, 4, 1
    v_lshlrev_b32 v52, 6, v52
    v_and_b32 v53, 15, v0
    v_lshl_add_u32 v52, v53, 1, v52
    v_lshl_add_u32 v52, v48, 5, v52
    v_add_u32 v52, s91, v52
    buffer_load_dwordx4 v[32:35], v51, s[12:15], s100 offen sc1
    buffer_load_dwordx2 v[16:17], v50, s[12:15], s99 offen offset:0 sc1
    buffer_load_dwordx2 v[18:19], v50, s[12:15], s99 offen offset:512 sc1
    buffer_load_dwordx2 v[20:21], v50, s[12:15], s99 offen offset:1024 sc1
    buffer_load_dwordx2 v[22:23], v50, s[12:15], s99 offen offset:1536 sc1
    buffer_load_dwordx2 v[24:25], v50, s[12:15], s99 offen offset:2048 sc1
    buffer_load_dwordx2 v[26:27], v50, s[12:15], s99 offen offset:2560 sc1
    buffer_load_dwordx2 v[28:29], v50, s[12:15], s99 offen offset:3072 sc1
    buffer_load_dwordx2 v[30:31], v50, s[12:15], s99 offen offset:3584 sc1
Lsp_89:
    ds_read_b32 v54, v3 offset:36
    s_waitcnt lgkmcnt(0)
    v_readfirstlane_b32 s91, v54
    s_nop 0
    s_cmp_ge_i32 s91, 4
    s_cbranch_scc1 Lspe_90
    s_sub_u32 s11, s11, 1
    s_cbranch_scc1 L_abort
    s_branch Lsp_89
Lspe_90:
    s_sleep 1
    s_mov_b64 s[42:43], exec
Lpl_91:
    buffer_load_dwordx4 v[32:35], v51, s[12:15], s100 offen sc1
    buffer_load_dwordx2 v[16:17], v50, s[12:15], s99 offen offset:0 sc1
    buffer_load_dwordx2 v[18:19], v50, s[12:15], s99 offen offset:512 sc1
    buffer_load_dwordx2 v[20:21], v50, s[12:15], s99 offen offset:1024 sc1
    buffer_load_dwordx2 v[22:23], v50, s[12:15], s99 offen offset:1536 sc1
    buffer_load_dwordx2 v[24:25], v50, s[12:15], s99 offen offset:2048 sc1
    buffer_load_dwordx2 v[26:27], v50, s[12:15], s99 offen offset:2560 sc1
    buffer_load_dwordx2 v[28:29], v50, s[12:15], s99 offen offset:3072 sc1
    buffer_load_dwordx2 v[30:31], v50, s[12:15], s99 offen offset:3584 sc1
    s_waitcnt vmcnt(0)
    v_xor_b32 v54, s10, v33
    v_bitop3_b32 v54, v54, v35, s10 bitop3:0xf6
    v_bitop3_b32 v54, v54, v17, s10 bitop3:0xf6
    v_bitop3_b32 v54, v54, v19, s10 bitop3:0xf6
    v_bitop3_b32 v54, v54, v21, s10 bitop3:0xf6
    v_bitop3_b32 v54, v54, v23, s10 bitop3:0xf6
    v_bitop3_b32 v54, v54, v25, s10 bitop3:0xf6
    v_bitop3_b32 v54, v54, v27, s10 bitop3:0xf6
    v_bitop3_b32 v54, v54, v29, s10 bitop3:0xf6
    v_bitop3_b32 v54, v54, v31, s10 bitop3:0xf6
    v_cmp_ne_u32 vcc, 0, v54
    s_cbranch_vccz Lple_92
    s_mov_b64 exec, vcc
    s_sub_u32 s11, s11, 1
    s_cbranch_scc1 L_abort
    s_branch Lpl_91
Lple_92:
    s_mov_b64 exec, s[42:43]
    v_mov_b32 v55, v32
    s_nop 1
    v_max_f32_dpp v55, v55, v55 quad_perm:[1,0,3,2] row_mask:0xf bank_mask:0xf
    s_nop 1
    v_max_f32_dpp v55, v55, v55 quad_perm:[2,3,0,1] row_mask:0xf bank_mask:0xf
    s_nop 1
    v_max_f32_dpp v55, v55, v55 row_half_mirror row_mask:0xf bank_mask:0xf
    v_mov_b32 v56, v55
    s_nop 1
    v_permlane32_swap_b32 v55, v56
    v_max_f32 v55, v55, v56
    s_mov_b32 s94, 0x3fb8aa3b
    v_sub_f32 v56, v32, v55
    v_lshlrev_b32 v36, 16, v16
    v_and_b32 v37, 0xffff0000, v16
    v_lshlrev_b32 v38, 16, v18
    v_and_b32 v39, 0xffff0000, v18
    v_lshlrev_b32 v40, 16, v20
    v_and_b32 v41, 0xffff0000, v20
    v_lshlrev_b32 v42, 16, v22
    v_and_b32 v43, 0xffff0000, v22
    v_mul_f32 v56, s94, v56
    v_exp_f32 v56, v56
    v_lshlrev_b32 v44, 16, v24
    v_and_b32 v45, 0xffff0000, v24
    v_lshlrev_b32 v46, 16, v26
    v_and_b32 v47, 0xffff0000, v26
    v_lshlrev_b32 v48, 16, v28
    v_and_b32 v49, 0xffff0000, v28
    v_lshlrev_b32 v50, 16, v30
    v_and_b32 v51, 0xffff0000, v30
    v_mul_f32 v57, v56, v34
    s_nop 1
    v_add_f32_dpp v57, v57, v57 quad_perm:[1,0,3,2] row_mask:0xf bank_mask:0xf
    s_nop 1
    v_add_f32_dpp v57, v57, v57 quad_perm:[2,3,0,1] row_mask:0xf bank_mask:0xf
    s_nop 1
    v_add_f32_dpp v57, v57, v57 row_half_mirror row_mask:0xf bank_mask:0xf
    v_mov_b32 v58, v57
    s_nop 1
    v_permlane32_swap_b32 v57, v58
    v_add_f32 v57, v57, v58
    v_rcp_f32 v57, v57
    v_mov_b32 v58, 0
    v_mov_b32 v59, 0
    v_mul_f32 v56, v56, v57
    s_nop 1
    v_fmac_f32_dpp v58, v56, v36 row_newbcast:0 row_mask:0xf bank_mask:0xf
    v_fmac_f32_dpp v59, v56, v37 row_newbcast:0 row_mask:0xf bank_mask:0xf
    s_nop 0
    v_fmac_f32_dpp v58, v56, v38 row_newbcast:1 row_mask:0xf bank_mask:0xf
    v_fmac_f32_dpp v59, v56, v39 row_newbcast:1 row_mask:0xf bank_mask:0xf
    s_nop 0
    v_fmac_f32_dpp v58, v56, v40 row_newbcast:2 row_mask:0xf bank_mask:0xf
    v_fmac_f32_dpp v59, v56, v41 row_newbcast:2 row_mask:0xf bank_mask:0xf
    s_nop 0
    v_fmac_f32_dpp v58, v56, v42 row_newbcast:3 row_mask:0xf bank_mask:0xf
    v_fmac_f32_dpp v59, v56, v43 row_newbcast:3 row_mask:0xf bank_mask:0xf
    s_nop 0
    v_fmac_f32_dpp v58, v56, v44 row_newbcast:4 row_mask:0xf bank_mask:0xf
    v_fmac_f32_dpp v59, v56, v45 row_newbcast:4 row_mask:0xf bank_mask:0xf
    s_nop 0
    v_fmac_f32_dpp v58, v56, v46 row_newbcast:5 row_mask:0xf bank_mask:0xf
    v_fmac_f32_dpp v59, v56, v47 row_newbcast:5 row_mask:0xf bank_mask:0xf
    s_nop 0
    v_fmac_f32_dpp v58, v56, v48 row_newbcast:6 row_mask:0xf bank_mask:0xf
    v_fmac_f32_dpp v59, v56, v49 row_newbcast:6 row_mask:0xf bank_mask:0xf
    s_nop 0
    v_fmac_f32_dpp v58, v56, v50 row_newbcast:7 row_mask:0xf bank_mask:0xf
    v_fmac_f32_dpp v59, v56, v51 row_newbcast:7 row_mask:0xf bank_mask:0xf
    s_nop 1
    v_permlane32_swap_b32 v58, v59
    v_add_f32 v58, v58, v59
    v_cvt_pk_bf16_f32 v58, v58, v58
    ds_write_b16 v52, v58 offset:1920
    s_waitcnt lgkmcnt(0)
    v_mov_b32 v43, s10
    v_mov_b32 v45, s10
    v_mov_b32 v47, s10
    s_barrier
Lsp_94:
    ds_read_b32 v15, v3 offset:40
    s_waitcnt lgkmcnt(0)
    v_readfirstlane_b32 s91, v15
    s_nop 0
    s_cmp_ge_i32 s91, 4
    s_cbranch_scc1 Lspe_95
    s_sub_u32 s11, s11, 1
    s_cbranch_scc1 L_abort
    s_branch Lsp_94
Lspe_95:
    s_sleep 8
    buffer_load_dwordx4 v[16:19], v7, s[12:15], s20 offen offset:0 sc1
    buffer_load_dwordx4 v[20:23], v7, s[12:15], s20 offen offset:1024 sc1
    buffer_load_dwordx4 v[24:27], v7, s[12:15], s20 offen offset:2048 sc1
    buffer_load_dwordx4 v[28:31], v7, s[12:15], s20 offen offset:3072 sc1
    s_sleep 6
L_p2_s5:
    buffer_load_dwordx4 v[64:67], v7, s[12:15], s20 offen offset:0 sc1
    buffer_load_dwordx4 v[68:71], v7, s[12:15], s20 offen offset:1024 sc1
    buffer_load_dwordx4 v[72:75], v7, s[12:15], s20 offen offset:2048 sc1
    buffer_load_dwordx4 v[76:79], v7, s[12:15], s20 offen offset:3072 sc1
    s_waitcnt vmcnt(4)
    v_xor_b32 v15, s10, v17
    v_bitop3_b32 v15, v15, v19, s10 bitop3:0xf6
    v_bitop3_b32 v15, v15, v21, s10 bitop3:0xf6
    v_bitop3_b32 v15, v15, v23, s10 bitop3:0xf6
    v_bitop3_b32 v15, v15, v25, s10 bitop3:0xf6
    v_bitop3_b32 v15, v15, v27, s10 bitop3:0xf6
    v_bitop3_b32 v15, v15, v29, s10 bitop3:0xf6
    v_bitop3_b32 v15, v15, v31, s10 bitop3:0xf6
    v_cmp_ne_u32 vcc, 0, v15
    s_cbranch_vccz L_p2a_s5
    s_sub_u32 s11, s11, 1
    s_cbranch_scc1 L_abort
    buffer_load_dwordx4 v[16:19], v7, s[12:15], s20 offen offset:0 sc1
    buffer_load_dwordx4 v[20:23], v7, s[12:15], s20 offen offset:1024 sc1
    buffer_load_dwordx4 v[24:27], v7, s[12:15], s20 offen offset:2048 sc1
    buffer_load_dwordx4 v[28:31], v7, s[12:15], s20 offen offset:3072 sc1
    s_waitcnt vmcnt(4)
    v_xor_b32 v15, s10, v65
    v_bitop3_b32 v15, v15, v67, s10 bitop3:0xf6
    v_bitop3_b32 v15, v15, v69, s10 bitop3:0xf6
    v_bitop3_b32 v15, v15, v71, s10 bitop3:0xf6
    v_bitop3_b32 v15, v15, v73, s10 bitop3:0xf6
    v_bitop3_b32 v15, v15, v75, s10 bitop3:0xf6
    v_bitop3_b32 v15, v15, v77, s10 bitop3:0xf6
    v_bitop3_b32 v15, v15, v79, s10 bitop3:0xf6
    v_cmp_ne_u32 vcc, 0, v15
    s_cbranch_vccnz L_p2_s5
    v_dot2_f32_bf16 v32, v64, v100, 0
    v_dot2_f32_bf16 v33, v64, v101, 0
    v_dot2_f32_bf16 v34, v66, v100, 0
    v_dot2_f32_bf16 v35, v66, v101, 0
    v_dot2_f32_bf16 v36, v72, v100, 0
    v_dot2_f32_bf16 v37, v72, v101, 0
    v_dot2_f32_bf16 v38, v74, v100, 0
    v_dot2_f32_bf16 v39, v74, v101, 0
    v_dot2_f32_bf16 v32, v68, v100, v32
    v_dot2_f32_bf16 v33, v68, v101, v33
    v_dot2_f32_bf16 v34, v70, v100, v34
    v_dot2_f32_bf16 v35, v70, v101, v35
    v_dot2_f32_bf16 v36, v76, v100, v36
    v_dot2_f32_bf16 v37, v76, v101, v37
    v_dot2_f32_bf16 v38, v78, v100, v38
    v_dot2_f32_bf16 v39, v78, v101, v39
    s_branch L_p2e_s5
L_p2a_s5:
    v_dot2_f32_bf16 v32, v16, v100, 0
    v_dot2_f32_bf16 v33, v16, v101, 0
    v_dot2_f32_bf16 v34, v18, v100, 0
    v_dot2_f32_bf16 v35, v18, v101, 0
    v_dot2_f32_bf16 v36, v24, v100, 0
    v_dot2_f32_bf16 v37, v24, v101, 0
    v_dot2_f32_bf16 v38, v26, v100, 0
    v_dot2_f32_bf16 v39, v26, v101, 0
    v_dot2_f32_bf16 v32, v20, v100, v32
    v_dot2_f32_bf16 v33, v20, v101, v33
    v_dot2_f32_bf16 v34, v22, v100, v34
    v_dot2_f32_bf16 v35, v22, v101, v35
    v_dot2_f32_bf16 v36, v28, v100, v36
    v_dot2_f32_bf16 v37, v28, v101, v37
    v_dot2_f32_bf16 v38, v30, v100, v38
    v_dot2_f32_bf16 v39, v30, v101, v39
L_p2e_s5:
    v_permlane32_swap_b32 v32, v36
    v_permlane32_swap_b32 v33, v37
    v_permlane32_swap_b32 v34, v38
    v_permlane32_swap_b32 v35, v39
    v_add_f32 v32, v32, v36
    v_add_f32 v33, v33, v37
    v_add_f32 v34, v34, v38
    v_add_f32 v35, v35, v39
    s_nop 0
    v_permlane16_swap_b32 v32, v34
    v_permlane16_swap_b32 v33, v35
    v_add_f32 v32, v32, v34
    v_add_f32 v33, v33, v35
    v_cndmask_b32 v36, v32, v33, s[26:27]
    v_cndmask_b32 v37, v33, v32, s[26:27]
    s_nop 1
    v_add_f32_dpp v36, v37, v36 row_ror:8 row_mask:0xf bank_mask:0xf
    s_nop 1
    v_add_f32_dpp v40, v36, v36 row_shl:4 row_mask:0xf bank_mask:0x5
    s_nop 1
    v_add_f32_dpp v40, v36, v36 row_shr:4 row_mask:0xf bank_mask:0xa
    v_cvt_pk_bf16_f32 v40, v40, v40
    v_lshlrev_b32 v40, 16, v40
    v_mul_f32 v40, v40, v103
    v_cvt_pk_bf16_f32 v40, v40, v40
    v_lshlrev_b32 v40, 16, v40
    v_add_f32 v102, v102, v40
    v_cvt_pk_bf16_f32 v102, v102, v102
    v_lshlrev_b32 v102, 16, v102
    s_nop 1
    v_mov_b32_dpp v41, v102 row_ror:8 row_mask:0xf bank_mask:0xf
    v_cvt_pk_bf16_f32 v42, v102, v41
    v_mul_f32 v46, v102, v102
    v_mov_b32 v44, v102
    s_mov_b32 exec_lo, 0x000f000f
    s_mov_b32 exec_hi, 0x000f000f
    s_cmp_eq_u32 s88, 1
    s_cbranch_scc1 Lst_96
    buffer_store_dwordx2 v[42:43], v98, s[12:15], s22 offen sc1
    s_branch Lste_97
Lst_96:
    buffer_store_dwordx2 v[42:43], v98, s[12:15], s22 offen
Lste_97:
    s_mov_b64 exec, -1
    v_add_f32_dpp v44, v44, v44 quad_perm:[1,0,3,2] row_mask:0xf bank_mask:0xf
    v_add_f32_dpp v46, v46, v46 quad_perm:[1,0,3,2] row_mask:0xf bank_mask:0xf
    s_nop 0
    v_add_f32_dpp v44, v44, v44 quad_perm:[2,3,0,1] row_mask:0xf bank_mask:0xf
    v_add_f32_dpp v46, v46, v46 quad_perm:[2,3,0,1] row_mask:0xf bank_mask:0xf
    s_nop 0
    v_add_f32_dpp v44, v44, v44 row_ror:8 row_mask:0xf bank_mask:0xf
    v_add_f32_dpp v46, v46, v46 row_ror:8 row_mask:0xf bank_mask:0xf
    v_mov_b32 v48, v44
    v_mov_b32 v49, v46
    s_nop 0
    v_permlane16_swap_b32 v44, v48
    v_permlane16_swap_b32 v46, v49
    v_add_f32 v44, v44, v48
    v_add_f32 v46, v46, v49
    s_mov_b32 exec_lo, 1
    s_mov_b32 exec_hi, 1
    s_cmp_eq_u32 s88, 1
    s_cbranch_scc1 Lst_98
    buffer_store_dwordx4 v[44:47], v99, s[12:15], s23 offen sc1
    s_branch Lste_99
Lst_98:
    buffer_store_dwordx4 v[44:47], v99, s[12:15], s23 offen
Lste_99:
    s_mov_b64 exec, -1
    v_mov_b32 v15, 1
    s_mov_b64 s[92:93], exec
    s_mov_b64 exec, 1
    ds_add_u32 v3, v15 offset:44
    s_mov_b64 exec, s[92:93]
    s_and_b32 s90, s5, 7
    s_cmp_lg_u32 s90, s4
    s_cbranch_scc1 L_slice_nf
    s_barrier
    s_barrier
    s_add_u32 s20, s17, 1703936
Lsp_100:
    ds_read_b32 v15, v3 offset:52
    s_waitcnt lgkmcnt(0)
    v_readfirstlane_b32 s91, v15
    s_nop 0
    s_cmp_ge_i32 s91, 4
    s_cbranch_scc1 Lspe_101
    s_sub_u32 s11, s11, 1
    s_cbranch_scc1 L_abort
    s_branch Lsp_100
Lspe_101:
    s_sleep 6
    s_waitcnt vmcnt(0)
    buffer_load_dwordx4 v[16:19], v7, s[12:15], s20 offen offset:0 sc1
    buffer_load_dwordx4 v[20:23], v7, s[12:15], s20 offen offset:1024 sc1
    buffer_load_dwordx4 v[24:27], v7, s[12:15], s20 offen offset:2048 sc1
    buffer_load_dwordx4 v[28:31], v7, s[12:15], s20 offen offset:3072 sc1
    s_sleep 6
L_p2_s8:
    buffer_load_dwordx4 v[64:67], v7, s[12:15], s20 offen offset:0 sc1
    buffer_load_dwordx4 v[68:71], v7, s[12:15], s20 offen offset:1024 sc1
    buffer_load_dwordx4 v[72:75], v7, s[12:15], s20 offen offset:2048 sc1
    buffer_load_dwordx4 v[76:79], v7, s[12:15], s20 offen offset:3072 sc1
    s_waitcnt vmcnt(4)
    v_xor_b32 v15, s10, v17
    v_bitop3_b32 v15, v15, v19, s10 bitop3:0xf6
    v_bitop3_b32 v15, v15, v21, s10 bitop3:0xf6
    v_bitop3_b32 v15, v15, v23, s10 bitop3:0xf6
    v_bitop3_b32 v15, v15, v25, s10 bitop3:0xf6
    v_bitop3_b32 v15, v15, v27, s10 bitop3:0xf6
    v_bitop3_b32 v15, v15, v29, s10 bitop3:0xf6
    v_bitop3_b32 v15, v15, v31, s10 bitop3:0xf6
    v_cmp_ne_u32 vcc, 0, v15
    s_cbranch_vccz L_p2a_s8
    s_sub_u32 s11, s11, 1
    s_cbranch_scc1 L_abort
    buffer_load_dwordx4 v[16:19], v7, s[12:15], s20 offen offset:0 sc1
    buffer_load_dwordx4 v[20:23], v7, s[12:15], s20 offen offset:1024 sc1
    buffer_load_dwordx4 v[24:27], v7, s[12:15], s20 offen offset:2048 sc1
    buffer_load_dwordx4 v[28:31], v7, s[12:15], s20 offen offset:3072 sc1
    s_waitcnt vmcnt(4)
    v_xor_b32 v15, s10, v65
    v_bitop3_b32 v15, v15, v67, s10 bitop3:0xf6
    v_bitop3_b32 v15, v15, v69, s10 bitop3:0xf6
    v_bitop3_b32 v15, v15, v71, s10 bitop3:0xf6
    v_bitop3_b32 v15, v15, v73, s10 bitop3:0xf6
    v_bitop3_b32 v15, v15, v75, s10 bitop3:0xf6
    v_bitop3_b32 v15, v15, v77, s10 bitop3:0xf6
    v_bitop3_b32 v15, v15, v79, s10 bitop3:0xf6
    v_cmp_ne_u32 vcc, 0, v15
    s_cbranch_vccnz L_p2_s8
    v_dot2_f32_bf16 v32, v64, v100, 0
    v_dot2_f32_bf16 v33, v64, v101, 0
    v_dot2_f32_bf16 v34, v66, v100, 0
    v_dot2_f32_bf16 v35, v66, v101, 0
    v_dot2_f32_bf16 v36, v72, v100, 0
    v_dot2_f32_bf16 v37, v72, v101, 0
    v_dot2_f32_bf16 v38, v74, v100, 0
    v_dot2_f32_bf16 v39, v74, v101, 0
    v_dot2_f32_bf16 v32, v68, v100, v32
    v_dot2_f32_bf16 v33, v68, v101, v33
    v_dot2_f32_bf16 v34, v70, v100, v34
    v_dot2_f32_bf16 v35, v70, v101, v35
    v_dot2_f32_bf16 v36, v76, v100, v36
    v_dot2_f32_bf16 v37, v76, v101, v37
    v_dot2_f32_bf16 v38, v78, v100, v38
    v_dot2_f32_bf16 v39, v78, v101, v39
    s_branch L_p2e_s8
L_p2a_s8:
    v_dot2_f32_bf16 v32, v16, v100, 0
    v_dot2_f32_bf16 v33, v16, v101, 0
    v_dot2_f32_bf16 v34, v18, v100, 0
    v_dot2_f32_bf16 v35, v18, v101, 0
    v_dot2_f32_bf16 v36, v24, v100, 0
    v_dot2_f32_bf16 v37, v24, v101, 0
    v_dot2_f32_bf16 v38, v26, v100, 0
    v_dot2_f32_bf16 v39, v26, v101, 0
    v_dot2_f32_bf16 v32, v20, v100, v32
    v_dot2_f32_bf16 v33, v20, v101, v33
    v_dot2_f32_bf16 v34, v22, v100, v34
    v_dot2_f32_bf16 v35, v22, v101, v35
    v_dot2_f32_bf16 v36, v28, v100, v36
    v_dot2_f32_bf16 v37, v28, v101, v37
    v_dot2_f32_bf16 v38, v30, v100, v38
    v_dot2_f32_bf16 v39, v30, v101, v39
L_p2e_s8:
    v_permlane32_swap_b32 v32, v36
    v_permlane32_swap_b32 v33, v37
    v_permlane32_swap_b32 v34, v38
    v_permlane32_swap_b32 v35, v39
    v_add_f32 v32, v32, v36
    v_add_f32 v33, v33, v37
    v_add_f32 v34, v34, v38
    v_add_f32 v35, v35, v39
    s_nop 0
    v_permlane16_swap_b32 v32, v34
    v_permlane16_swap_b32 v33, v35
    v_add_f32 v32, v32, v34
    v_add_f32 v33, v33, v35
    v_cndmask_b32 v36, v32, v33, s[26:27]
    v_cndmask_b32 v37, v33, v32, s[26:27]
    s_nop 1
    v_add_f32_dpp v36, v37, v36 row_ror:8 row_mask:0xf bank_mask:0xf
    s_nop 1
    v_add_f32_dpp v40, v36, v36 row_shl:4 row_mask:0xf bank_mask:0x5
    s_nop 1
    v_add_f32_dpp v40, v36, v36 row_shr:4 row_mask:0xf bank_mask:0xa
    v_cvt_pk_bf16_f32 v40, v40, v40
    v_lshlrev_b32 v40, 16, v40
    v_mul_f32 v40, v40, v104
    v_cvt_pk_bf16_f32 v40, v40, v40
    v_lshlrev_b32 v40, 16, v40
    v_add_f32 v102, v102, v40
    v_cvt_pk_bf16_f32 v102, v102, v102
    v_lshlrev_b32 v102, 16, v102
    s_nop 1
    v_mov_b32_dpp v41, v102 row_ror:8 row_mask:0xf bank_mask:0xf
    v_cvt_pk_bf16_f32 v42, v102, v41
    s_mov_b32 exec_lo, 0x000f000f
    s_mov_b32 exec_hi, 0x000f000f
    buffer_store_dword v42, v97, s[48:51], s24 offen
    s_cmp_lg_u32 s2, 0
    s_cbranch_scc1 L_slice_end
    s_mov_b64 exec, 1
    v_mov_b32 v24, s89
    v_mov_b32 v21, 0
    buffer_store_dword v24, v21, s[12:15], 0 offen sc1
L_slice_end:
    s_mov_b64 exec, -1
    s_endpgm
L_slice_nf:
    s_barrier
    s_barrier
    s_endpgm
L_aux:
    s_mov_b32 s44, s28
    s_and_b32 s45, s29, 0xffff
    s_mov_b32 s46, 1835008
    s_mov_b32 s47, 0x20000
    s_mov_b32 s48, s30
    s_and_b32 s49, s31, 0xffff
    s_mov_b32 s50, 1835008
    s_mov_b32 s51, 0x20000
    s_mov_b32 s52, s32
    s_and_b32 s53, s33, 0xffff
    s_mov_b32 s54, 1835008
    s_mov_b32 s55, 0x20000
    v_mov_b32 v10, 1
    s_mul_i32 s18, s4, 229376
    s_mul_i32 s94, s8, 57344
    s_add_u32 s18, s18, s94
    s_lshl_b32 s94, s9, 7
    s_add_u32 s18, s18, s94
    s_mul_i32 s19, s8, 458752
    s_mul_i32 s94, s4, 448
    s_add_u32 s19, s19, s94
    s_lshl_b32 s94, s9, 6
    s_add_u32 s19, s19, s94
    s_waitcnt vmcnt(0)
    v_readfirstlane_b32 s89, v3
    s_nop 0
    s_add_u32 s89, s89, 1
    s_mul_i32 s10, s89, 0x9E3779B1
    v_lshrrev_b32 v6, 2, v0
    v_mul_u32_u24 v64, 3584, v6
    v_bfe_u32 v6, v0, 5, 1
    v_lshlrev_b32 v6, 1, v6
    v_and_b32 v7, 3, v0
    v_xor_b32 v6, v6, v7
    v_lshl_add_u32 v64, v6, 4, v64
    v_lshrrev_b32 v3, 3, v0
    v_bfe_u32 v4, v0, 4, 1
    v_lshlrev_b32 v4, 1, v4
    v_and_b32 v5, 7, v0
    v_xor_b32 v4, v4, v5
    v_lshlrev_b32 v4, 4, v4
    v_lshlrev_b32 v6, 10, v3
    v_add_u32 v66, v6, v4
    v_xor_b32 v67, 64, v66
    v_mov_b32 v3, 0
    s_cmp_lg_u32 s6, 0
    s_cbranch_scc1 Lgx_102
Lsp_103:
    ds_read_b32 v50, v3 offset:0
    s_waitcnt lgkmcnt(0)
    v_readfirstlane_b32 s91, v50
    s_nop 0
    s_cmp_ge_i32 s91, 16
    s_cbranch_scc1 Lspe_104
    s_sub_u32 s11, s11, 1
    s_cbranch_scc1 L_abort
    s_sleep 1
    s_branch Lsp_103
Lspe_104:
Lgx_102:
    s_mov_b32 s60, s40
    s_and_b32 s61, s41, 0xffff
    s_mov_b32 s62, 256
    s_mov_b32 s63, 0x20000
    s_lshl_b32 s91, s4, 5
    s_add_u32 s91, s91, 8
    v_mov_b32 v18, s91
    s_getreg_b32 s90, hwreg(HW_REG_XCC_ID)
    s_and_b32 s90, s90, 7
    s_mul_i32 s90, s90, 6
    s_lshl_b64 s[26:27], 1, s90
    s_mov_b64 exec, 1
Lxc_105:
    buffer_load_dwordx2 v[20:21], v18, s[60:63], 0 offen sc1
    s_waitcnt vmcnt(0)
    v_readfirstlane_b32 s20, v20
    v_readfirstlane_b32 s21, v21
    s_nop 0
    s_mov_b64 s[22:23], s[20:21]
    s_mov_b32 s90, 0
    s_and_b32 s91, s22, 63
    s_add_u32 s90, s90, s91
    s_lshr_b64 s[22:23], s[22:23], 6
    s_and_b32 s91, s22, 63
    s_add_u32 s90, s90, s91
    s_lshr_b64 s[22:23], s[22:23], 6
    s_and_b32 s91, s22, 63
    s_add_u32 s90, s90, s91
    s_lshr_b64 s[22:23], s[22:23], 6
    s_and_b32 s91, s22, 63
    s_add_u32 s90, s90, s91
    s_lshr_b64 s[22:23], s[22:23], 6
    s_and_b32 s91, s22, 63
    s_add_u32 s90, s90, s91
    s_lshr_b64 s[22:23], s[22:23], 6
    s_and_b32 s91, s22, 63
    s_add_u32 s90, s90, s91
    s_lshr_b64 s[22:23], s[22:23], 6
    s_and_b32 s91, s22, 63
    s_add_u32 s90, s90, s91
    s_lshr_b64 s[22:23], s[22:23], 6
    s_and_b32 s91, s22, 63
    s_add_u32 s90, s90, s91
    s_cmp_ge_u32 s90, 32
    s_cbranch_scc1 Lxce_106
    s_sub_u32 s11, s11, 1
    s_cbranch_scc1 L_abort
    s_sleep 2
    s_branch Lxc_105
Lxce_106:
    s_lshl_b64 s[22:23], s[26:27], 5
    s_cmp_eq_u64 s[20:21], s[22:23]
    s_cselect_b32 s90, 1, 2
    v_mov_b32 v16, s90
    ds_write_b32 v3, v16 offset:80
    s_mov_b64 exec, -1
    s_cmp_lg_u32 s6, 0
    s_cbranch_scc1 L_aux_ga
    s_cmp_ge_u32 s7, 16
    s_cbranch_scc1 L_aux_ga
    s_lshr_b32 s90, s4, 1
    s_and_b32 s91, s4, 1
    s_lshr_b32 s22, s7, 2
    s_and_b32 s23, s7, 3
    s_lshl_b32 s20, s90, 15
    s_lshl_b32 s94, s91, 14
    s_add_u32 s20, s20, s94
    s_lshl_b32 s94, s22, 12
    s_add_u32 s20, s20, s94
    s_lshl_b32 s94, s23, 8
    s_add_u32 s20, s20, s94
    s_add_u32 s20, s20, 69632
    s_lshl_b32 s21, s90, 12
    s_lshl_b32 s94, s91, 11
    s_add_u32 s21, s21, s94
    s_lshl_b32 s94, s7, 7
    s_add_u32 s21, s21, s94
    s_add_u32 s21, s21, 237568
    v_lshlrev_b32 v18, 3, v0
    s_mov_b32 exec_hi, 0
Lsp_107:
    ds_read_b32 v50, v3 offset:0
    s_waitcnt lgkmcnt(0)
    v_readfirstlane_b32 s91, v50
    s_nop 0
    s_cmp_ge_i32 s91, 16
    s_cbranch_scc1 Lspe_108
    s_sub_u32 s11, s11, 1
    s_cbranch_scc1 L_abort
    s_sleep 1
    s_branch Lsp_107
Lspe_108:
    s_mov_b64 s[42:43], exec
Lpl_109:
    buffer_load_dwordx2 v[40:41], v18, s[12:15], s20 offen offset:0 sc1
    buffer_load_dwordx2 v[42:43], v18, s[12:15], s20 offen offset:1024 sc1
    buffer_load_dwordx2 v[44:45], v18, s[12:15], s20 offen offset:2048 sc1
    buffer_load_dwordx2 v[46:47], v18, s[12:15], s20 offen offset:3072 sc1
    s_waitcnt vmcnt(0)
    v_xor_b32 v60, s10, v41
    v_bitop3_b32 v60, v60, v43, s10 bitop3:0xf6
    v_bitop3_b32 v60, v60, v45, s10 bitop3:0xf6
    v_bitop3_b32 v60, v60, v47, s10 bitop3:0xf6
    v_cmp_ne_u32 vcc, 0, v60
    s_cbranch_vccz Lple_110
    s_mov_b64 exec, vcc
    s_sub_u32 s11, s11, 1
    s_cbranch_scc1 L_abort
    s_sleep 6
    s_branch Lpl_109
Lple_110:
    s_mov_b64 exec, s[42:43]
    v_add_f32 v40, v40, v42
    v_add_f32 v44, v44, v46
    v_add_f32 v40, v40, v44
    v_lshlrev_b32 v18, 2, v0
    v_mov_b32 v43, s10
    v_mov_b32_dpp v42, v40 quad_perm:[1,0,3,2] row_mask:0xf bank_mask:0xf
    s_mov_b32 exec_lo, 0x55555555
    v_cvt_pk_bf16_f32 v42, v40, v42
    buffer_store_dwordx2 v[42:43], v18, s[12:15], s21 offen sc1
    s_mov_b64 exec, -1
L_aux_ga:
    s_mul_i32 s99, s6, -45
    s_add_u32 s99, s99, 100
Lsp_112:
    ds_read_b32 v50, v3 offset:0
    s_waitcnt lgkmcnt(0)
    v_readfirstlane_b32 s91, v50
    s_nop 0
    s_cmp_ge_i32 s91, s99
    s_cbranch_scc1 Lspe_113
    s_sub_u32 s11, s11, 1
    s_cbranch_scc1 L_abort
    s_sleep 1
    s_branch Lsp_112
Lspe_113:
    s_lshl_b32 s20, s5, 6
    s_add_u32 s20, s20, 237568
    s_add_u32 s21, s20, 12288
    v_bfe_u32 v16, v0, 3, 1
    v_and_b32 v17, 7, v0
    v_lshlrev_b32 v18, 11, v16
    v_lshl_add_u32 v18, v17, 3, v18
    v_and_b32 v19, 15, v0
    v_lshlrev_b32 v19, 3, v19
    s_mov_b64 exec, 0xffff
    s_mov_b64 s[42:43], exec
Lpl_114:
    buffer_load_dwordx2 v[40:41], v18, s[12:15], s20 offen sc1
    buffer_load_dwordx2 v[42:43], v18, s[12:15], s21 offen sc1
    s_waitcnt vmcnt(0)
    v_xor_b32 v60, s10, v41
    v_bitop3_b32 v60, v60, v43, s10 bitop3:0xf6
    v_cmp_ne_u32 vcc, 0, v60
    s_cbranch_vccz Lple_115
    s_mov_b64 exec, vcc
    s_sub_u32 s11, s11, 1
    s_cbranch_scc1 L_abort
    s_sleep 8
    s_branch Lpl_114
Lple_115:
    s_mov_b64 exec, s[42:43]
    v_lshlrev_b32 v44, 16, v40
    v_and_b32 v45, 0xffff0000, v40
    v_lshlrev_b32 v46, 16, v42
    v_and_b32 v47, 0xffff0000, v42
    ds_write_b64 v19, v[44:45] offset:7168
    ds_write_b64 v19, v[46:47] offset:7296
    s_mov_b64 exec, -1
    s_mov_b64 s[92:93], exec
    s_mov_b64 exec, 1
    ds_add_u32 v3, v10 offset:84
    s_mov_b64 exec, s[92:93]
    s_sub_u32 s90, s3, 4
    s_lshr_b32 s91, s90, 1
    s_and_b32 s94, s90, 1
    s_lshl_b32 s99, s94, 8
    s_lshl_b32 s100, s4, 16
    s_add_u32 s99, s99, s100
    s_lshl_b32 s100, s8, 14
    s_add_u32 s99, s99, s100
    s_lshl_b32 s100, s91, 13
    s_add_u32 s99, s99, s100
    s_add_u32 s99, s99, 589824
    s_lshl_b32 s100, s4, 11
    s_lshl_b32 s90, s91, 10
    s_add_u32 s100, s100, s90
    s_lshl_b32 s90, s8, 8
    s_add_u32 s100, s100, s90
    s_add_u32 s100, s100, 524288
    v_lshrrev_b32 v48, 5, v0
    v_and_b32 v49, 31, v0
    v_lshlrev_b32 v50, 12, v48
    v_lshl_add_u32 v50, v49, 3, v50
    v_and_b32 v51, 7, v0
    v_lshl_add_u32 v51, v48, 3, v51
    v_lshlrev_b32 v51, 4, v51
    s_mul_i32 s91, s91, 272
    s_lshl_b32 s94, s94, 7
    s_add_u32 s91, s91, s94
    v_bfe_u32 v52, v0, 4, 1
    v_lshlrev_b32 v52, 6, v52
    v_and_b32 v53, 15, v0
    v_lshl_add_u32 v52, v53, 1, v52
    v_lshl_add_u32 v52, v48, 5, v52
    v_add_u32 v52, s91, v52
    buffer_load_dwordx4 v[32:35], v51, s[12:15], s100 offen sc1
    buffer_load_dwordx2 v[16:17], v50, s[12:15], s99 offen offset:0 sc1
    buffer_load_dwordx2 v[18:19], v50, s[12:15], s99 offen offset:512 sc1
    buffer_load_dwordx2 v[20:21], v50, s[12:15], s99 offen offset:1024 sc1
    buffer_load_dwordx2 v[22:23], v50, s[12:15], s99 offen offset:1536 sc1
    buffer_load_dwordx2 v[24:25], v50, s[12:15], s99 offen offset:2048 sc1
    buffer_load_dwordx2 v[26:27], v50, s[12:15], s99 offen offset:2560 sc1
    buffer_load_dwordx2 v[28:29], v50, s[12:15], s99 offen offset:3072 sc1
    buffer_load_dwordx2 v[30:31], v50, s[12:15], s99 offen offset:3584 sc1
Lsp_117:
    ds_read_b32 v54, v3 offset:36
    s_waitcnt lgkmcnt(0)
    v_readfirstlane_b32 s91, v54
    s_nop 0
    s_cmp_ge_i32 s91, 4
    s_cbranch_scc1 Lspe_118
    s_sub_u32 s11, s11, 1
    s_cbranch_scc1 L_abort
    s_branch Lsp_117
Lspe_118:
    s_sleep 1
    s_mov_b64 s[42:43], exec
Lpl_119:
    buffer_load_dwordx4 v[32:35], v51, s[12:15], s100 offen sc1
    buffer_load_dwordx2 v[16:17], v50, s[12:15], s99 offen offset:0 sc1
    buffer_load_dwordx2 v[18:19], v50, s[12:15], s99 offen offset:512 sc1
    buffer_load_dwordx2 v[20:21], v50, s[12:15], s99 offen offset:1024 sc1
    buffer_load_dwordx2 v[22:23], v50, s[12:15], s99 offen offset:1536 sc1
    buffer_load_dwordx2 v[24:25], v50, s[12:15], s99 offen offset:2048 sc1
    buffer_load_dwordx2 v[26:27], v50, s[12:15], s99 offen offset:2560 sc1
    buffer_load_dwordx2 v[28:29], v50, s[12:15], s99 offen offset:3072 sc1
    buffer_load_dwordx2 v[30:31], v50, s[12:15], s99 offen offset:3584 sc1
    s_waitcnt vmcnt(0)
    v_xor_b32 v54, s10, v33
    v_bitop3_b32 v54, v54, v35, s10 bitop3:0xf6
    v_bitop3_b32 v54, v54, v17, s10 bitop3:0xf6
    v_bitop3_b32 v54, v54, v19, s10 bitop3:0xf6
    v_bitop3_b32 v54, v54, v21, s10 bitop3:0xf6
    v_bitop3_b32 v54, v54, v23, s10 bitop3:0xf6
    v_bitop3_b32 v54, v54, v25, s10 bitop3:0xf6
    v_bitop3_b32 v54, v54, v27, s10 bitop3:0xf6
    v_bitop3_b32 v54, v54, v29, s10 bitop3:0xf6
    v_bitop3_b32 v54, v54, v31, s10 bitop3:0xf6
    v_cmp_ne_u32 vcc, 0, v54
    s_cbranch_vccz Lple_120
    s_mov_b64 exec, vcc
    s_sub_u32 s11, s11, 1
    s_cbranch_scc1 L_abort
    s_branch Lpl_119
Lple_120:
    s_mov_b64 exec, s[42:43]
    v_mov_b32 v55, v32
    s_nop 1
    v_max_f32_dpp v55, v55, v55 quad_perm:[1,0,3,2] row_mask:0xf bank_mask:0xf
    s_nop 1
    v_max_f32_dpp v55, v55, v55 quad_perm:[2,3,0,1] row_mask:0xf bank_mask:0xf
    s_nop 1
    v_max_f32_dpp v55, v55, v55 row_half_mirror row_mask:0xf bank_mask:0xf
    v_mov_b32 v56, v55
    s_nop 1
    v_permlane32_swap_b32 v55, v56
    v_max_f32 v55, v55, v56
    s_mov_b32 s94, 0x3fb8aa3b
    v_sub_f32 v56, v32, v55
    v_lshlrev_b32 v36, 16, v16
    v_and_b32 v37, 0xffff0000, v16
    v_lshlrev_b32 v38, 16, v18
    v_and_b32 v39, 0xffff0000, v18
    v_lshlrev_b32 v40, 16, v20
    v_and_b32 v41, 0xffff0000, v20
    v_lshlrev_b32 v42, 16, v22
    v_and_b32 v43, 0xffff0000, v22
    v_mul_f32 v56, s94, v56
    v_exp_f32 v56, v56
    v_lshlrev_b32 v44, 16, v24
    v_and_b32 v45, 0xffff0000, v24
    v_lshlrev_b32 v46, 16, v26
    v_and_b32 v47, 0xffff0000, v26
    v_lshlrev_b32 v48, 16, v28
    v_and_b32 v49, 0xffff0000, v28
    v_lshlrev_b32 v50, 16, v30
    v_and_b32 v51, 0xffff0000, v30
    v_mul_f32 v57, v56, v34
    s_nop 1
    v_add_f32_dpp v57, v57, v57 quad_perm:[1,0,3,2] row_mask:0xf bank_mask:0xf
    s_nop 1
    v_add_f32_dpp v57, v57, v57 quad_perm:[2,3,0,1] row_mask:0xf bank_mask:0xf
    s_nop 1
    v_add_f32_dpp v57, v57, v57 row_half_mirror row_mask:0xf bank_mask:0xf
    v_mov_b32 v58, v57
    s_nop 1
    v_permlane32_swap_b32 v57, v58
    v_add_f32 v57, v57, v58
    v_rcp_f32 v57, v57
    v_mov_b32 v58, 0
    v_mov_b32 v59, 0
    v_mul_f32 v56, v56, v57
    s_nop 1
    v_fmac_f32_dpp v58, v56, v36 row_newbcast:0 row_mask:0xf bank_mask:0xf
    v_fmac_f32_dpp v59, v56, v37 row_newbcast:0 row_mask:0xf bank_mask:0xf
    s_nop 0
    v_fmac_f32_dpp v58, v56, v38 row_newbcast:1 row_mask:0xf bank_mask:0xf
    v_fmac_f32_dpp v59, v56, v39 row_newbcast:1 row_mask:0xf bank_mask:0xf
    s_nop 0
    v_fmac_f32_dpp v58, v56, v40 row_newbcast:2 row_mask:0xf bank_mask:0xf
    v_fmac_f32_dpp v59, v56, v41 row_newbcast:2 row_mask:0xf bank_mask:0xf
    s_nop 0
    v_fmac_f32_dpp v58, v56, v42 row_newbcast:3 row_mask:0xf bank_mask:0xf
    v_fmac_f32_dpp v59, v56, v43 row_newbcast:3 row_mask:0xf bank_mask:0xf
    s_nop 0
    v_fmac_f32_dpp v58, v56, v44 row_newbcast:4 row_mask:0xf bank_mask:0xf
    v_fmac_f32_dpp v59, v56, v45 row_newbcast:4 row_mask:0xf bank_mask:0xf
    s_nop 0
    v_fmac_f32_dpp v58, v56, v46 row_newbcast:5 row_mask:0xf bank_mask:0xf
    v_fmac_f32_dpp v59, v56, v47 row_newbcast:5 row_mask:0xf bank_mask:0xf
    s_nop 0
    v_fmac_f32_dpp v58, v56, v48 row_newbcast:6 row_mask:0xf bank_mask:0xf
    v_fmac_f32_dpp v59, v56, v49 row_newbcast:6 row_mask:0xf bank_mask:0xf
    s_nop 0
    v_fmac_f32_dpp v58, v56, v50 row_newbcast:7 row_mask:0xf bank_mask:0xf
    v_fmac_f32_dpp v59, v56, v51 row_newbcast:7 row_mask:0xf bank_mask:0xf
    s_nop 1
    v_permlane32_swap_b32 v58, v59
    v_add_f32 v58, v58, v59
    v_cvt_pk_bf16_f32 v58, v58, v58
    ds_write_b16 v52, v58 offset:1920
    s_waitcnt lgkmcnt(0)
    s_barrier
Lsp_122:
    ds_read_b32 v50, v3 offset:40
    s_waitcnt lgkmcnt(0)
    v_readfirstlane_b32 s91, v50
    s_nop 0
    s_cmp_ge_i32 s91, 4
    s_cbranch_scc1 Lspe_123
    s_sub_u32 s11, s11, 1
    s_cbranch_scc1 L_abort
    s_branch Lsp_122
Lspe_123:
    s_cmp_eq_u32 s9, 7
    s_cbranch_scc1 L_aux_gu_e
    s_mov_b32 m0, 28672
    s_mov_b32 s99, 8
L_aux_gu:
    buffer_load_dwordx4 v64, s[44:47], s19 offen nt lds
    s_add_u32 m0, m0, 0x2000
    s_nop 0
    buffer_load_dwordx4 v64, s[48:51], s19 offen nt lds
    s_sub_u32 m0, m0, 0x1c00
    s_add_u32 s19, s19, 57344
    s_sub_u32 s99, s99, 1
    s_cmp_lg_u32 s99, 0
    s_cbranch_scc1 L_aux_gu
L_aux_gu_e:
    s_waitcnt vmcnt(0)
    s_mov_b64 s[92:93], exec
    s_mov_b64 exec, 1
    ds_add_u32 v3, v10 offset:32
    s_mov_b64 exec, s[92:93]
L_aux_lateE:
    s_barrier
    s_barrier
    s_endpgm
L_abort:
    s_mov_b64 exec, 1
    v_mov_b32 v1, 0
    s_lshl_b32 s90, s2, 16
    v_mov_b32 v2, s90
    s_and_b32 s90, s3, 1
    s_lshl_b32 s90, s90, 2
    v_mov_b32 v1, s90
    v_or_b32 v2, 0xde000000, v2
    s_mov_b32 s44, s40
    s_and_b32 s45, s41, 0xffff
    s_mov_b32 s46, 256
    s_mov_b32 s47, 0x20000
    buffer_store_dword v2, v1, s[44:47], 0 offen
L_end:
    s_endpgm
.section .rodata,"a"
.p2align 6
.amdhsa_kernel adaLN_cond__sliding_block_cached__glu_gated_bilinear__decode_kernel
  .amdhsa_next_free_vgpr 128
  .amdhsa_next_free_sgpr 102
  .amdhsa_accum_offset 128
  .amdhsa_group_segment_fixed_size 0
  .amdhsa_kernarg_size 112
  .amdhsa_user_sgpr_count 2
  .amdhsa_user_sgpr_kernarg_segment_ptr 1
  .amdhsa_system_sgpr_workgroup_id_x 1
.end_amdhsa_kernel
```
